```python
import torch

def _softmax(x, axis=-1):
    return torch.softmax(x, dim=axis)

def _gelu(x):
    return torch.nn.functional.gelu(x, approximate='tanh')

def _silu(x):
    return torch.nn.functional.silu(x)

def _sigmoid(x):
    return torch.sigmoid(x)

def _layernorm(x, axis=-1, eps=1e-05):
    m = x.mean(dim=axis, keepdim=True)
    v = x.var(dim=axis, keepdim=True, unbiased=False)
    return (x - m) / torch.sqrt(v + eps)

def _scatter_add(tgt, idx, src, axis=0):
    return tgt.clone().index_add_(axis, idx, src)

def _segment_sum(src, seg, n):
    out = torch.zeros((n,) + src.shape[1:], dtype=src.dtype)
    return out.index_add_(0, seg, src)

def _pad(x, pw):
    flat = tuple((v for pair in reversed(pw) for v in pair))
    return torch.nn.functional.pad(x, flat)
kernel_name = 'adaLN_cond__grouped_kv_mqa__glu_gated_reglu__prompt'

def setup_inputs():

    _w = lambda a: (lambda t: t.to(torch.bfloat16) if t.is_floating_point() else t)(torch.as_tensor(a))

    def _A_setup():
        B, S, D, H = (1, 2048, 448, 16)
        Dh = D // H
        return {'x': _w((lambda *s: torch.randn(*s, dtype=torch.bfloat16) * 0.05)(B, S, D)), 'wq': _w((lambda *s: torch.randn(*s, dtype=torch.bfloat16) * 0.05)(D, H * Dh)), 'wk': _w((lambda *s: torch.randn(*s, dtype=torch.bfloat16) * 0.05)(D, Dh)), 'wv': _w((lambda *s: torch.randn(*s, dtype=torch.bfloat16) * 0.05)(D, Dh)), 'wo': _w((lambda *s: torch.randn(*s, dtype=torch.bfloat16) * 0.05)(H * Dh, D))}
    _A_in = _A_setup()

    def _B_setup():
        B, S, D, F = (1, 2048, 448, 1792)
        return {'x': _w((lambda *s: torch.randn(*s, dtype=torch.bfloat16) * 0.05)(B, S, D)), 'W_gate': _w((lambda *s: torch.randn(*s, dtype=torch.bfloat16) * 0.8)(D, F) * (2.0 / D) ** 0.5), 'W_up': _w((lambda *s: torch.randn(*s, dtype=torch.bfloat16) * 0.8)(D, F) * (2.0 / D) ** 0.5), 'W_down': _w((lambda *s: torch.randn(*s, dtype=torch.bfloat16) * 0.8)(F, D) * (1.0 / F) ** 0.5)}
    _B_in = _B_setup()
    return {'A_x': _A_in['x'], 'A_wq': _A_in['wq'], 'A_wk': _A_in['wk'], 'A_wv': _A_in['wv'], 'A_wo': _A_in['wo'], 'B_x': _B_in['x'], 'B_W_gate': _B_in['W_gate'], 'B_W_up': _B_in['W_up'], 'B_W_down': _B_in['W_down'], 'c': _w((lambda *s: torch.randn(*s, dtype=torch.bfloat16) * 0.2)(1, 448) * 8.0), 'w_mod': _w((lambda *s: torch.randn(*s, dtype=torch.bfloat16) * 0.2)(448, 6 * 448) * 448 ** (-0.5) * 8.0)}

def reference(A_x, A_wq, A_wk, A_wv, A_wo, B_x, B_W_gate, B_W_up, B_W_down, c, w_mod):

    def _A_ref(x, wq, wk, wv, wo):
        B, S, D = x.shape
        H = 16
        Dh = D // H
        q = (lambda x, *d: x.permute(*d))((x @ wq).reshape(B, S, H, Dh), 0, 2, 1, 3)
        k = x @ wk
        v = x @ wv
        scores = torch.einsum('bhqd,bkd->bhqk', q, k) * Dh ** (-0.5)
        p = _softmax(scores, axis=-1)
        o = torch.einsum('bhqk,bkd->bhqd', p, v)
        return (lambda x, *d: x.permute(*d))(o, 0, 2, 1, 3).reshape(B, S, H * Dh) @ wo

    def _B_ref(x, W_gate, W_up, W_down):
        gate = torch.einsum('bsd,df->bsf', x, W_gate)
        up = torch.einsum('bsd,df->bsf', x, W_up)
        gate = gate * (lambda x, dt: x.to(dt))(gate > 0, gate.dtype)
        h = gate * up
        return torch.einsum('bsf,fd->bsd', h, W_down)
    x = A_x
    mod = (_silu(c) @ w_mod).reshape(c.shape[0], 6, 1, -1)
    sa, ca, ga, sb, cb, gb = (mod[:, 0].clone(), mod[:, 1].clone(), mod[:, 2].clone(), mod[:, 3].clone(), mod[:, 4].clone(), mod[:, 5].clone())
    h = _layernorm(x, axis=-1) * (1 + ca) + sa
    x = x + ga * _A_ref(h, A_wq, A_wk, A_wv, A_wo)
    h = _layernorm(x, axis=-1) * (1 + cb) + sb
    x = x + gb * _B_ref(h, B_W_gate, B_W_up, B_W_down)
    return x
```

```asm
; @launch grid=(256,1,1) block=(512,1,1) lds=163840
.amdgcn_target "amdgcn-amd-amdhsa--gfx950"
.text
.globl adaLN_cond__grouped_kv_mqa__glu_gated_reglu__prompt_kernel
.p2align 8
.type adaLN_cond__grouped_kv_mqa__glu_gated_reglu__prompt_kernel,@function
adaLN_cond__grouped_kv_mqa__glu_gated_reglu__prompt_kernel:
  s_cmpk_ge_u32 s2, 256
  s_cbranch_scc1 Lend
  s_load_dwordx2 s[20:21], s[0:1], 80
  s_load_dwordx2 s[32:33], s[0:1], 72
  s_load_dwordx2 s[24:25], s[0:1], 104
  s_load_dwordx2 s[4:5], s[0:1], 0
  s_load_dwordx8 s[36:43], s[0:1], 8
  s_load_dwordx8 s[44:51], s[0:1], 40
  s_load_dwordx2 s[28:29], s[0:1], 88
  s_lshr_b32 s64, s2, 3
  s_mov_b32 s19, 0x20000
  s_getpc_b64 s[16:17]
Lpcbase:
  v_lshlrev_b32 v8, 7, v0
  s_and_b32 s63, s64, 7
  s_mov_b32 s18, Lcodeend-Lpcbase
  s_lshl_b32 exec_lo, 0x01010101, s63
  s_mov_b32 exec_hi, exec_lo
  buffer_load_dword v31, v8, s[16:19], 0 offen
  s_mov_b64 exec, -1
  v_lshrrev_b32 v6, 6, v0
  v_and_b32 v1, 63, v0
  s_and_b32 s68, s2, 7
  v_readfirstlane_b32 s3, v6
  s_lshr_b32 s65, s64, 2
  s_and_b32 s66, s64, 1
  s_lshl1_add_u32 s73, s65, s66
  s_and_b32 s69, s2, 6
  s_mul_i32 s69, s69, 7
  s_add_u32 s69, s69, s73
  s_lshl_b32 s53, s68, 5
  s_add_u32 s53, s53, s64
  v_lshlrev_b32 v2, 4, v1
  v_lshrrev_b32 v6, 3, v1
  v_and_b32 v7, 0x70, v2
  s_movk_i32 s63, 5376
  v_mad_u32_u24 v11, v6, s63, v7
  v_add_u32 v6, 8, v1
  v_lshrrev_b32 v6, 6, v6
  v_lshl_or_b32 v10, v6, 30, v2
  s_mov_b32 s22, 2408448
  s_mov_b32 s23, s19
  s_movk_i32 s34, 896
  s_mov_b32 s35, s19
  s_mov_b32 s6, 1835008
  s_mov_b32 s7, s19
  s_lshl3_add_u32 s74, s53, s3
  s_bitcmp1_b32 0x09999999, s64
  s_cselect_b32 s63, s68, 0
  s_bitcmp1_b32 s63, 0
  s_cselect_b32 s70, 1, 0
  s_cselect_b32 s67, s3, 0
  s_cbranch_scc0 Lnomod_1
  s_cmp_eq_u32 s67, 7
  s_cbranch_scc0 Lnomod_1_b
  s_setprio 3
  s_and_b32 s71, s69, 3
  s_lshl_b32 s64, s69, 5
  s_mul_i32 s63, s71, 602080
  s_add_u32 s63, s63, s64
  s_mov_b32 m0, 86016
  s_waitcnt lgkmcnt(0)
  buffer_load_dwordx4 v[12:15], v2, s[32:35], 0 offen
  s_mov_b32 s64, 41984
Lmodld_2:
  buffer_load_dwordx4 v11, s[20:23], s63 offen offset:0 lds
  s_add_u32 s63, s63, s64
  buffer_load_dwordx4 v11, s[20:23], s63 offen offset:1024 lds
  s_addk_i32 m0, 2048
  s_add_u32 s63, s63, 44032
  s_cmp_lt_u32 m0, 100352
  s_cbranch_scc1 Lmodld_2
Lnomod_1_b:
  s_barrier
Lnomod_1:
  s_mul_i32 s66, s74, s34
  s_waitcnt lgkmcnt(0)
  s_load_dword s58, s[24:25], 0
  buffer_load_dwordx4 v[16:19], v10, s[4:7], s66 offen
  s_xor_b32 s75, s74, 8
  s_mul_i32 s66, s75, s34
  buffer_load_dwordx4 v[20:23], v10, s[4:7], s66 offen
  s_xor_b32 s76, s74, 16
  s_mul_i32 s66, s76, s34
  buffer_load_dwordx4 v[24:27], v10, s[4:7], s66 offen
  s_xor_b32 s77, s74, 24
  s_mul_i32 s66, s77, s34
  buffer_load_dwordx4 v[28:31], v10, s[4:7], s66 offen
  s_and_b32 s52, s3, 3
  s_mov_b32 s15, s19
  s_cmp_ge_u32 s3, 4
  s_cbranch_scc1 Lloader
  s_lshr_b32 s54, s53, 2
  s_and_b32 s55, s53, 3
  s_mov_b32 s26, 33554432
  s_mov_b32 s27, 0x20000
  s_getreg_b32 s60, hwreg(HW_REG_XCC_ID, 0, 4)
  s_lshr_b32 s56, s53, 4
  s_and_b32 s57, s53, 15
  s_mov_b32 s59, 0x100000
  s_lshl2_add_u32 s62, s53, s52
  s_lshl_b32 s62, s62, 2
  v_and_b32 v4, 15, v1
  v_lshrrev_b32 v5, 4, v1
  v_min_u32 v6, 896, v2
  s_mul_i32 s65, s3, 928
  s_add_u32 s65, s65, 129536
  v_add_u32 v36, s65, v6
  v_add_u32 v37, 153600, v2
  s_and_b32 s65, s74, 31
  s_mul_i32 s65, s65, 912
  s_add_u32 s65, s65, 100352
  v_add_u32 v32, s65, v6
  s_and_b32 s65, s75, 31
  s_mul_i32 s65, s65, 912
  s_add_u32 s65, s65, 100352
  v_add_u32 v33, s65, v6
  s_and_b32 s65, s76, 31
  s_mul_i32 s65, s65, 912
  s_add_u32 s65, s65, 100352
  v_add_u32 v34, s65, v6
  s_and_b32 s65, s77, 31
  s_mul_i32 s65, s65, 912
  s_add_u32 s65, s65, 100352
  v_add_u32 v35, s65, v6
  s_mov_b64 s[8:9], s[36:37]
  s_mov_b32 s10, 401408
  s_mov_b32 s11, 0x20000
  s_and_b32 s63, s52, 1
  s_mul_i32 s63, s63, 13312
  s_mul_i32 s64, s52, 13312
  s_add_u32 m0, s64, 100352
  s_movk_i32 s14, 25088
  s_cmp_lt_u32 s52, 2
  s_cselect_b64 s[12:13], s[38:39], s[40:41]
  v_mul_u32_u24 v6, 4682, v1
  v_lshrrev_b32 v6, 16, v6
  v_mul_u32_u24 v7, 14, v6
  v_sub_u32 v7, v1, v7
  v_and_b32 v8, 1, v6
  v_lshrrev_b32 v6, 1, v6
  v_lshl_add_u32 v6, v8, 2, v6
  v_mul_u32_u24 v6, 896, v6
  v_lshl_add_u32 v12, v7, 4, v6
  v_add_u32 v13, 896, v12
  s_mul_i32 s69, s52, 7168
  s_mul_i32 s64, s55, 224
  s_add_u32 s69, s69, s64
  s_mul_i32 s71, s52, 1792
  v_and_b32 v7, 1, v4
  v_lshlrev_b32 v7, 4, v7
  v_and_b32 v9, 2, v4
  v_lshl_add_u32 v9, v9, 2, v7
  v_lshrrev_b32 v6, 2, v4
  v_lshrrev_b32 v7, 1, v5
  v_lshl_add_u32 v6, v7, 2, v6
  v_mul_u32_u24 v6, 448, v6
  v_and_b32 v8, 1, v5
  v_lshl_add_u32 v6, v8, 5, v6
  s_mul_i32 s65, s52, 56
  v_add3_u32 v14, v6, v9, s65
  v_add_u32 v15, 50176, v14
  v_and_b32 v6, 31, v1
  v_mul_u32_u24 v6, 912, v6
  v_lshl_add_u32 v6, v7, 4, v6
  v_add_u32 v11, 100352, v6
  v_and_b32 v6, 7, v1
  v_lshlrev_b32 v6, 4, v6
  v_lshl_add_u32 v6, v7, 7, v6
  v_add_u32 v38, 161792, v6
  s_lshl_b32 s65, s52, 11
  s_add_u32 s65, s65, 153600
  v_add_u32 v39, s65, v2
  s_add_u32 s64, s52, 1
  s_and_b32 s64, s64, 3
  s_lshl_b32 s65, s64, 11
  s_add_u32 s65, s65, 153600
  v_add_u32 v48, s65, v2
  s_mul_i32 s64, s64, 12288
  s_add_u32 s64, s64, 114688
  v_add_u32 v44, s64, v2
  s_add_u32 s64, s52, 2
  s_and_b32 s64, s64, 3
  s_lshl_b32 s65, s64, 11
  s_add_u32 s65, s65, 153600
  v_add_u32 v49, s65, v2
  s_mul_i32 s64, s64, 12288
  s_add_u32 s64, s64, 118784
  v_add_u32 v45, s64, v2
  s_add_u32 s64, s52, 3
  s_and_b32 s64, s64, 3
  s_lshl_b32 s65, s64, 11
  s_add_u32 s65, s65, 153600
  v_add_u32 v50, s65, v2
  s_mul_i32 s64, s64, 12288
  s_add_u32 s64, s64, 122880
  v_add_u32 v46, s64, v2
  s_add_u32 s64, s52, 4
  s_and_b32 s64, s64, 3
  s_mul_i32 s64, s64, 12288
  s_add_u32 s64, s64, 114688
  v_add_u32 v47, s64, v2
  v_and_b32 v6, 51, v1
  v_and_b32 v7, 4, v1
  v_lshl_or_b32 v6, v7, 1, v6
  v_bfe_u32 v7, v1, 3, 1
  v_lshl_or_b32 v6, v7, 2, v6
  v_lshlrev_b32 v40, 4, v6
  s_lshl_b32 s72, s52, 16
  s_add_u32 s72, s72, 262144
  s_add_u32 s73, s72, 65536
  s_mov_b32 s78, 2146435072
  s_lshl_b32 s79, s52, 12
  s_add_u32 s79, s79, 16384
  v_lshlrev_b32 v51, 6, v1
  v_add_u32 v41, 4096, v40
  v_add_u32 v42, 8192, v40
  v_add_u32 v43, 12288, v40
  v_mov_b32 v192, 0
  v_mov_b32 v193, 0
  v_mov_b32 v194, 0
  v_mov_b32 v195, 0
  v_mov_b32 v196, 0
  v_mov_b32 v197, 0
  v_mov_b32 v198, 0
  v_mov_b32 v199, 0
  v_mov_b32 v200, 0
  v_mov_b32 v201, 0
  v_mov_b32 v202, 0
  v_mov_b32 v203, 0
  v_mov_b32 v204, 0
  v_mov_b32 v205, 0
  v_mov_b32 v206, 0
  v_mov_b32 v207, 0
  v_mov_b32 v208, 0
  v_mov_b32 v209, 0
  v_mov_b32 v210, 0
  v_mov_b32 v211, 0
  v_mov_b32 v212, 0
  v_mov_b32 v213, 0
  v_mov_b32 v214, 0
  v_mov_b32 v215, 0
  v_mov_b32 v216, 0
  v_mov_b32 v217, 0
  v_mov_b32 v218, 0
  v_mov_b32 v219, 0
  v_mov_b32 v220, 0
  v_mov_b32 v221, 0
  v_mov_b32 v222, 0
  v_mov_b32 v223, 0
  s_cmp_eq_u32 s70, 0
  s_cbranch_scc0 Lnob0a
  s_barrier
Lnob0a:
  buffer_load_dwordx4 v2, s[12:15], s63 offen offset:0 lds
  buffer_load_dwordx4 v2, s[12:15], s63 offen offset:1024 lds
  buffer_load_dwordx4 v2, s[12:15], s63 offen offset:2048 lds
  buffer_load_dwordx4 v2, s[12:15], s63 offen offset:3072 lds
  s_addk_i32 m0, 4096
  s_addk_i32 s63, 4096
  buffer_load_dwordx4 v2, s[12:15], s63 offen offset:0 lds
  buffer_load_dwordx4 v2, s[12:15], s63 offen offset:1024 lds
  buffer_load_dwordx4 v2, s[12:15], s63 offen offset:2048 lds
  buffer_load_dwordx4 v2, s[12:15], s63 offen offset:3072 lds
  v_mov_b32 v10, 0x3f803f80
  s_waitcnt vmcnt(11)
  v_dot2_f32_bf16 v54, v16, v10, 0
  v_dot2_f32_bf16 v58, v16, v16, 0
  s_waitcnt vmcnt(10)
  v_dot2_f32_bf16 v55, v20, v10, 0
  v_dot2_f32_bf16 v59, v20, v20, 0
  s_waitcnt vmcnt(9)
  v_dot2_f32_bf16 v56, v24, v10, 0
  v_dot2_f32_bf16 v60, v24, v24, 0
  s_waitcnt vmcnt(8)
  v_dot2_f32_bf16 v57, v28, v10, 0
  v_dot2_f32_bf16 v61, v28, v28, 0
  v_dot2_f32_bf16 v54, v17, v10, v54
  v_dot2_f32_bf16 v58, v17, v17, v58
  v_dot2_f32_bf16 v55, v21, v10, v55
  v_dot2_f32_bf16 v59, v21, v21, v59
  v_dot2_f32_bf16 v56, v25, v10, v56
  v_dot2_f32_bf16 v60, v25, v25, v60
  v_dot2_f32_bf16 v57, v29, v10, v57
  v_dot2_f32_bf16 v61, v29, v29, v61
  v_dot2_f32_bf16 v54, v18, v10, v54
  v_dot2_f32_bf16 v58, v18, v18, v58
  v_dot2_f32_bf16 v55, v22, v10, v55
  v_dot2_f32_bf16 v59, v22, v22, v59
  v_dot2_f32_bf16 v56, v26, v10, v56
  v_dot2_f32_bf16 v60, v26, v26, v60
  v_dot2_f32_bf16 v57, v30, v10, v57
  v_dot2_f32_bf16 v61, v30, v30, v61
  v_dot2_f32_bf16 v54, v19, v10, v54
  v_dot2_f32_bf16 v58, v19, v19, v58
  v_dot2_f32_bf16 v55, v23, v10, v55
  v_dot2_f32_bf16 v59, v23, v23, v59
  v_dot2_f32_bf16 v56, v27, v10, v56
  v_dot2_f32_bf16 v60, v27, v27, v60
  v_dot2_f32_bf16 v57, v31, v10, v57
  v_dot2_f32_bf16 v61, v31, v31, v61
  v_lshlrev_b32 v64, 16, v16
  v_and_b32 v65, 0xffff0000, v16
  v_lshlrev_b32 v66, 16, v17
  v_and_b32 v67, 0xffff0000, v17
  v_permlane32_swap_b32 v54, v55
  v_permlane32_swap_b32 v56, v57
  v_permlane32_swap_b32 v58, v59
  v_permlane32_swap_b32 v60, v61
  v_add_f32 v54, v54, v55
  v_add_f32 v56, v56, v57
  v_add_f32 v58, v58, v59
  v_add_f32 v60, v60, v61
  v_lshlrev_b32 v68, 16, v18
  v_and_b32 v69, 0xffff0000, v18
  v_permlane16_swap_b32 v54, v56
  v_permlane16_swap_b32 v58, v60
  v_add_f32 v54, v54, v56
  v_add_f32 v58, v58, v60
  v_lshlrev_b32 v70, 16, v19
  v_and_b32 v71, 0xffff0000, v19
  v_add_f32_dpp v54, v54, v54 row_ror:8 row_mask:0xf bank_mask:0xf
  v_add_f32_dpp v58, v58, v58 row_ror:8 row_mask:0xf bank_mask:0xf
  v_lshlrev_b32 v72, 16, v20
  v_and_b32 v73, 0xffff0000, v20
  v_add_f32_dpp v54, v54, v54 row_ror:4 row_mask:0xf bank_mask:0xf
  v_add_f32_dpp v58, v58, v58 row_ror:4 row_mask:0xf bank_mask:0xf
  v_lshlrev_b32 v74, 16, v21
  v_and_b32 v75, 0xffff0000, v21
  v_add_f32_dpp v54, v54, v54 row_ror:2 row_mask:0xf bank_mask:0xf
  v_add_f32_dpp v58, v58, v58 row_ror:2 row_mask:0xf bank_mask:0xf
  v_lshlrev_b32 v76, 16, v22
  v_and_b32 v77, 0xffff0000, v22
  v_add_f32_dpp v54, v54, v54 row_ror:1 row_mask:0xf bank_mask:0xf
  v_add_f32_dpp v58, v58, v58 row_ror:1 row_mask:0xf bank_mask:0xf
  v_mul_f32 v54, 0xbb124925, v54
  v_mul_f32 v58, 0x3b124925, v58
  v_fma_f32 v58, -v54, v54, v58
  v_max_f32 v58, 0, v58
  v_add_f32 v58, 0x3727c5ac, v58
  v_rsq_f32 v58, v58
  v_lshlrev_b32 v78, 16, v23
  v_and_b32 v79, 0xffff0000, v23
  v_mul_f32 v54, v54, v58
  v_lshlrev_b32 v80, 16, v24
  v_and_b32 v81, 0xffff0000, v24
  v_readlane_b32 s80, v58, 0
  v_readlane_b32 s81, v54, 0
  v_readlane_b32 s82, v58, 32
  v_readlane_b32 s83, v54, 32
  v_readlane_b32 s84, v58, 16
  v_readlane_b32 s85, v54, 16
  v_readlane_b32 s86, v58, 48
  v_readlane_b32 s87, v54, 48
  v_lshlrev_b32 v82, 16, v25
  v_and_b32 v83, 0xffff0000, v25
  v_lshlrev_b32 v84, 16, v26
  v_and_b32 v85, 0xffff0000, v26
  v_lshlrev_b32 v86, 16, v27
  v_and_b32 v87, 0xffff0000, v27
  v_lshlrev_b32 v88, 16, v28
  v_and_b32 v89, 0xffff0000, v28
  v_lshlrev_b32 v90, 16, v29
  v_and_b32 v91, 0xffff0000, v29
  v_lshlrev_b32 v92, 16, v30
  v_and_b32 v93, 0xffff0000, v30
  v_lshlrev_b32 v94, 16, v31
  v_and_b32 v95, 0xffff0000, v31
  v_pk_fma_f32 v[64:65], v[64:65], s[80:81], s[80:81] op_sel:[0,0,1] op_sel_hi:[1,0,1]
  v_pk_fma_f32 v[66:67], v[66:67], s[80:81], s[80:81] op_sel:[0,0,1] op_sel_hi:[1,0,1]
  v_pk_fma_f32 v[68:69], v[68:69], s[80:81], s[80:81] op_sel:[0,0,1] op_sel_hi:[1,0,1]
  v_pk_fma_f32 v[70:71], v[70:71], s[80:81], s[80:81] op_sel:[0,0,1] op_sel_hi:[1,0,1]
  v_pk_fma_f32 v[72:73], v[72:73], s[82:83], s[82:83] op_sel:[0,0,1] op_sel_hi:[1,0,1]
  v_pk_fma_f32 v[74:75], v[74:75], s[82:83], s[82:83] op_sel:[0,0,1] op_sel_hi:[1,0,1]
  v_pk_fma_f32 v[76:77], v[76:77], s[82:83], s[82:83] op_sel:[0,0,1] op_sel_hi:[1,0,1]
  v_pk_fma_f32 v[78:79], v[78:79], s[82:83], s[82:83] op_sel:[0,0,1] op_sel_hi:[1,0,1]
  v_pk_fma_f32 v[80:81], v[80:81], s[84:85], s[84:85] op_sel:[0,0,1] op_sel_hi:[1,0,1]
  v_pk_fma_f32 v[82:83], v[82:83], s[84:85], s[84:85] op_sel:[0,0,1] op_sel_hi:[1,0,1]
  v_pk_fma_f32 v[84:85], v[84:85], s[84:85], s[84:85] op_sel:[0,0,1] op_sel_hi:[1,0,1]
  v_pk_fma_f32 v[86:87], v[86:87], s[84:85], s[84:85] op_sel:[0,0,1] op_sel_hi:[1,0,1]
  v_pk_fma_f32 v[88:89], v[88:89], s[86:87], s[86:87] op_sel:[0,0,1] op_sel_hi:[1,0,1]
  v_pk_fma_f32 v[90:91], v[90:91], s[86:87], s[86:87] op_sel:[0,0,1] op_sel_hi:[1,0,1]
  v_pk_fma_f32 v[92:93], v[92:93], s[86:87], s[86:87] op_sel:[0,0,1] op_sel_hi:[1,0,1]
  v_pk_fma_f32 v[94:95], v[94:95], s[86:87], s[86:87] op_sel:[0,0,1] op_sel_hi:[1,0,1]
  s_addk_i32 m0, 4096
  s_addk_i32 s63, 4096
  buffer_load_dwordx4 v2, s[12:15], s63 offen offset:0 lds
  buffer_load_dwordx4 v2, s[12:15], s63 offen offset:1024 lds
  buffer_load_dwordx4 v2, s[12:15], s63 offen offset:2048 lds
  buffer_load_dwordx4 v2, s[12:15], s63 offen offset:3072 lds
  s_addk_i32 m0, 4096
  s_addk_i32 s63, 4096
  buffer_load_dwordx4 v2, s[12:15], s63 offen offset:0 lds
  s_waitcnt lgkmcnt(0)
  s_and_b32 s58, s58, 0xfffffff0
  s_add_u32 s58, s58, 0x9e3779b0
  v_mov_b32 v3, s58
  s_mov_b32 exec_hi, 0x00ffffff
  s_add_u32 m0, s71, 0
  s_nop 0
  buffer_load_dwordx4 v12, s[8:11], s69 offen lds
  buffer_load_dwordx4 v13, s[8:11], s69 offen offset:896 lds
  s_add_u32 m0, s71, 7168
  s_add_u32 s69, s69, 28672
  buffer_load_dwordx4 v12, s[8:11], s69 offen lds
  buffer_load_dwordx4 v13, s[8:11], s69 offen offset:896 lds
  s_add_u32 m0, s71, 14336
  s_add_u32 s69, s69, 28672
  buffer_load_dwordx4 v12, s[8:11], s69 offen lds
  buffer_load_dwordx4 v13, s[8:11], s69 offen offset:896 lds
  s_add_u32 m0, s71, 21504
  s_add_u32 s69, s69, 28672
  buffer_load_dwordx4 v12, s[8:11], s69 offen lds
  buffer_load_dwordx4 v13, s[8:11], s69 offen offset:896 lds
  s_mov_b32 exec_hi, -1
  s_waitcnt vmcnt(8)
  s_barrier
  s_barrier
  s_mov_b32 exec_hi, 0x00ffffff
  s_add_u32 m0, s71, 28672
  s_add_u32 s69, s69, 28672
  buffer_load_dwordx4 v12, s[8:11], s69 offen lds
  buffer_load_dwordx4 v13, s[8:11], s69 offen offset:896 lds
  s_add_u32 m0, s71, 35840
  s_add_u32 s69, s69, 28672
  buffer_load_dwordx4 v12, s[8:11], s69 offen lds
  buffer_load_dwordx4 v13, s[8:11], s69 offen offset:896 lds
  s_add_u32 m0, s71, 43008
  s_add_u32 s69, s69, 28672
  buffer_load_dwordx4 v12, s[8:11], s69 offen lds
  buffer_load_dwordx4 v13, s[8:11], s69 offen offset:896 lds
  s_add_u32 m0, s71, 50176
  s_add_u32 s69, s69, 28672
  buffer_load_dwordx4 v12, s[8:11], s69 offen lds
  buffer_load_dwordx4 v13, s[8:11], s69 offen offset:896 lds
  s_add_u32 m0, s71, 57344
  s_add_u32 s69, s69, 28672
  buffer_load_dwordx4 v12, s[8:11], s69 offen lds
  buffer_load_dwordx4 v13, s[8:11], s69 offen offset:896 lds
  s_add_u32 m0, s71, 64512
  s_add_u32 s69, s69, 28672
  buffer_load_dwordx4 v12, s[8:11], s69 offen lds
  buffer_load_dwordx4 v13, s[8:11], s69 offen offset:896 lds
  s_mov_b32 exec_hi, -1
  s_barrier
  ds_read_b128 v[104:107], v37 offset:1792
  ds_read_b128 v[96:99], v37 offset:0
  ds_read_b128 v[108:111], v37 offset:2688
  ds_read_b128 v[100:103], v37 offset:896
  s_waitcnt lgkmcnt(2)
  v_pk_fma_f32 v[64:65], v[64:65], v[104:105], v[96:97]
  v_pk_fma_f32 v[66:67], v[66:67], v[106:107], v[98:99]
  v_cvt_pk_bf16_f32 v16, v64, v65
  s_waitcnt lgkmcnt(0)
  v_pk_fma_f32 v[68:69], v[68:69], v[108:109], v[100:101]
  v_cvt_pk_bf16_f32 v17, v66, v67
  v_pk_fma_f32 v[70:71], v[70:71], v[110:111], v[102:103]
  v_cvt_pk_bf16_f32 v18, v68, v69
  v_cvt_pk_bf16_f32 v19, v70, v71
  ds_write_b128 v36, v[16:19]
  s_waitcnt vmcnt(16)
  s_waitcnt lgkmcnt(0)
  s_barrier
  s_mov_b32 exec_hi, 0x00ffffff
  s_add_u32 m0, s71, 71680
  s_add_u32 s69, s69, 28672
  buffer_load_dwordx4 v12, s[8:11], s69 offen lds
  buffer_load_dwordx4 v13, s[8:11], s69 offen offset:896 lds
  s_add_u32 m0, s71, 78848
  s_add_u32 s69, s69, 28672
  buffer_load_dwordx4 v12, s[8:11], s69 offen lds
  buffer_load_dwordx4 v13, s[8:11], s69 offen offset:896 lds
  s_add_u32 m0, s71, 86016
  s_add_u32 s69, s69, 28672
  buffer_load_dwordx4 v12, s[8:11], s69 offen lds
  buffer_load_dwordx4 v13, s[8:11], s69 offen offset:896 lds
  s_add_u32 m0, s71, 93184
  s_add_u32 s69, s69, 28672
  buffer_load_dwordx4 v12, s[8:11], s69 offen lds
  buffer_load_dwordx4 v13, s[8:11], s69 offen offset:896 lds
  s_mov_b32 exec_hi, -1
  v_pk_fma_f32 v[72:73], v[72:73], v[104:105], v[96:97]
  v_pk_fma_f32 v[74:75], v[74:75], v[106:107], v[98:99]
  v_pk_fma_f32 v[76:77], v[76:77], v[108:109], v[100:101]
  v_pk_fma_f32 v[78:79], v[78:79], v[110:111], v[102:103]
  v_cvt_pk_bf16_f32 v20, v72, v73
  v_cvt_pk_bf16_f32 v21, v74, v75
  v_cvt_pk_bf16_f32 v22, v76, v77
  v_cvt_pk_bf16_f32 v23, v78, v79
  v_pk_fma_f32 v[80:81], v[80:81], v[104:105], v[96:97]
  v_pk_fma_f32 v[82:83], v[82:83], v[106:107], v[98:99]
  v_pk_fma_f32 v[84:85], v[84:85], v[108:109], v[100:101]
  v_pk_fma_f32 v[86:87], v[86:87], v[110:111], v[102:103]
  v_cvt_pk_bf16_f32 v24, v80, v81
  v_cvt_pk_bf16_f32 v25, v82, v83
  v_cvt_pk_bf16_f32 v26, v84, v85
  v_cvt_pk_bf16_f32 v27, v86, v87
  v_pk_fma_f32 v[88:89], v[88:89], v[104:105], v[96:97]
  v_pk_fma_f32 v[90:91], v[90:91], v[106:107], v[98:99]
  v_pk_fma_f32 v[92:93], v[92:93], v[108:109], v[100:101]
  v_pk_fma_f32 v[94:95], v[94:95], v[110:111], v[102:103]
  v_cvt_pk_bf16_f32 v28, v88, v89
  v_cvt_pk_bf16_f32 v29, v90, v91
  v_cvt_pk_bf16_f32 v30, v92, v93
  v_cvt_pk_bf16_f32 v31, v94, v95
  ds_write_b128 v32, v[16:19]
  ds_write_b128 v33, v[20:23]
  ds_write_b128 v34, v[24:27]
  ds_write_b128 v35, v[28:31]
  ds_read_b64_tr_b16 v[112:113], v14 offset:0
  ds_read_b64_tr_b16 v[114:115], v14 offset:224
  ds_read_b64_tr_b16 v[116:117], v14 offset:3584
  ds_read_b64_tr_b16 v[118:119], v14 offset:3808
  ds_read_b64_tr_b16 v[120:121], v14 offset:7168
  ds_read_b64_tr_b16 v[122:123], v14 offset:7392
  ds_read_b64_tr_b16 v[124:125], v14 offset:10752
  ds_read_b64_tr_b16 v[126:127], v14 offset:10976
  s_waitcnt vmcnt(0)
  s_waitcnt lgkmcnt(0)
  s_barrier
  ds_read_b128 v[136:139], v11 offset:0
  ds_read_b128 v[140:143], v11 offset:32
  ds_read_b128 v[144:147], v11 offset:64
  ds_read_b128 v[148:151], v11 offset:96
  s_mov_b32 s74, 0x3e8b97f6
  s_mov_b32 s75, 0x3e8b97f6
  ds_read_b64_tr_b16 v[128:129], v14 offset:14336
  ds_read_b64_tr_b16 v[130:131], v14 offset:14560
  ds_read_b128 v[152:155], v11 offset:128
  s_waitcnt lgkmcnt(6)
  v_mfma_f32_32x32x16_bf16 v[160:175], v[112:115], v[136:139], 0
  ds_read_b64_tr_b16 v[132:133], v14 offset:17920
  ds_read_b64_tr_b16 v[134:135], v14 offset:18144
  ds_read_b128 v[156:159], v11 offset:160
  s_waitcnt lgkmcnt(8)
  v_mfma_f32_32x32x16_bf16 v[160:175], v[116:119], v[140:143], v[160:175]
  ds_read_b64_tr_b16 v[112:113], v14 offset:21504
  ds_read_b64_tr_b16 v[114:115], v14 offset:21728
  ds_read_b128 v[136:139], v11 offset:192
  s_waitcnt lgkmcnt(10)
  v_mfma_f32_32x32x16_bf16 v[160:175], v[120:123], v[144:147], v[160:175]
  ds_read_b64_tr_b16 v[116:117], v14 offset:25088
  ds_read_b64_tr_b16 v[118:119], v14 offset:25312
  ds_read_b128 v[140:143], v11 offset:224
  s_waitcnt lgkmcnt(12)
  v_mfma_f32_32x32x16_bf16 v[160:175], v[124:127], v[148:151], v[160:175]
  ds_read_b64_tr_b16 v[120:121], v14 offset:28672
  ds_read_b64_tr_b16 v[122:123], v14 offset:28896
  ds_read_b128 v[144:147], v11 offset:256
  s_waitcnt lgkmcnt(12)
  v_mfma_f32_32x32x16_bf16 v[160:175], v[128:131], v[152:155], v[160:175]
  ds_read_b64_tr_b16 v[124:125], v14 offset:32256
  ds_read_b64_tr_b16 v[126:127], v14 offset:32480
  ds_read_b128 v[148:151], v11 offset:288
  s_waitcnt lgkmcnt(12)
  v_mfma_f32_32x32x16_bf16 v[160:175], v[132:135], v[156:159], v[160:175]
  ds_read_b64_tr_b16 v[128:129], v14 offset:35840
  ds_read_b64_tr_b16 v[130:131], v14 offset:36064
  ds_read_b128 v[152:155], v11 offset:320
  s_waitcnt lgkmcnt(12)
  v_mfma_f32_32x32x16_bf16 v[160:175], v[112:115], v[136:139], v[160:175]
  ds_read_b64_tr_b16 v[132:133], v14 offset:39424
  ds_read_b64_tr_b16 v[134:135], v14 offset:39648
  ds_read_b128 v[156:159], v11 offset:352
  s_waitcnt lgkmcnt(12)
  v_mfma_f32_32x32x16_bf16 v[160:175], v[116:119], v[140:143], v[160:175]
  ds_read_b64_tr_b16 v[112:113], v14 offset:43008
  ds_read_b64_tr_b16 v[114:115], v14 offset:43232
  ds_read_b128 v[136:139], v11 offset:384
  s_waitcnt lgkmcnt(12)
  v_mfma_f32_32x32x16_bf16 v[160:175], v[120:123], v[144:147], v[160:175]
  ds_read_b64_tr_b16 v[116:117], v14 offset:46592
  ds_read_b64_tr_b16 v[118:119], v14 offset:46816
  ds_read_b128 v[140:143], v11 offset:416
  s_waitcnt lgkmcnt(12)
  v_mfma_f32_32x32x16_bf16 v[160:175], v[124:127], v[148:151], v[160:175]
  ds_read_b64_tr_b16 v[120:121], v15 offset:0
  ds_read_b64_tr_b16 v[122:123], v15 offset:224
  ds_read_b128 v[144:147], v11 offset:448
  s_waitcnt lgkmcnt(12)
  v_mfma_f32_32x32x16_bf16 v[160:175], v[128:131], v[152:155], v[160:175]
  ds_read_b64_tr_b16 v[124:125], v15 offset:3584
  ds_read_b64_tr_b16 v[126:127], v15 offset:3808
  ds_read_b128 v[148:151], v11 offset:480
  s_waitcnt lgkmcnt(12)
  v_mfma_f32_32x32x16_bf16 v[160:175], v[132:135], v[156:159], v[160:175]
  ds_read_b64_tr_b16 v[128:129], v15 offset:7168
  ds_read_b64_tr_b16 v[130:131], v15 offset:7392
  ds_read_b128 v[152:155], v11 offset:512
  s_waitcnt lgkmcnt(12)
  v_mfma_f32_32x32x16_bf16 v[160:175], v[112:115], v[136:139], v[160:175]
  ds_read_b64_tr_b16 v[132:133], v15 offset:10752
  ds_read_b64_tr_b16 v[134:135], v15 offset:10976
  ds_read_b128 v[156:159], v11 offset:544
  s_waitcnt lgkmcnt(12)
  v_mfma_f32_32x32x16_bf16 v[160:175], v[116:119], v[140:143], v[160:175]
  ds_read_b64_tr_b16 v[112:113], v15 offset:14336
  ds_read_b64_tr_b16 v[114:115], v15 offset:14560
  ds_read_b128 v[136:139], v11 offset:576
  s_waitcnt lgkmcnt(12)
  v_mfma_f32_32x32x16_bf16 v[160:175], v[120:123], v[144:147], v[160:175]
  ds_read_b64_tr_b16 v[116:117], v15 offset:17920
  ds_read_b64_tr_b16 v[118:119], v15 offset:18144
  ds_read_b128 v[140:143], v11 offset:608
  s_waitcnt lgkmcnt(12)
  v_mfma_f32_32x32x16_bf16 v[160:175], v[124:127], v[148:151], v[160:175]
  ds_read_b64_tr_b16 v[120:121], v15 offset:21504
  ds_read_b64_tr_b16 v[122:123], v15 offset:21728
  ds_read_b128 v[144:147], v11 offset:640
  s_waitcnt lgkmcnt(12)
  v_mfma_f32_32x32x16_bf16 v[160:175], v[128:131], v[152:155], v[160:175]
  ds_read_b64_tr_b16 v[124:125], v15 offset:25088
  ds_read_b64_tr_b16 v[126:127], v15 offset:25312
  ds_read_b128 v[148:151], v11 offset:672
  s_waitcnt lgkmcnt(12)
  v_mfma_f32_32x32x16_bf16 v[160:175], v[132:135], v[156:159], v[160:175]
  ds_read_b64_tr_b16 v[128:129], v15 offset:28672
  ds_read_b64_tr_b16 v[130:131], v15 offset:28896
  ds_read_b128 v[152:155], v11 offset:704
  s_waitcnt lgkmcnt(12)
  v_mfma_f32_32x32x16_bf16 v[160:175], v[112:115], v[136:139], v[160:175]
  ds_read_b64_tr_b16 v[132:133], v15 offset:32256
  ds_read_b64_tr_b16 v[134:135], v15 offset:32480
  ds_read_b128 v[156:159], v11 offset:736
  s_waitcnt lgkmcnt(12)
  v_mfma_f32_32x32x16_bf16 v[160:175], v[116:119], v[140:143], v[160:175]
  ds_read_b64_tr_b16 v[112:113], v15 offset:35840
  ds_read_b64_tr_b16 v[114:115], v15 offset:36064
  ds_read_b128 v[136:139], v11 offset:768
  s_waitcnt lgkmcnt(12)
  v_mfma_f32_32x32x16_bf16 v[160:175], v[120:123], v[144:147], v[160:175]
  ds_read_b64_tr_b16 v[116:117], v15 offset:39424
  ds_read_b64_tr_b16 v[118:119], v15 offset:39648
  ds_read_b128 v[140:143], v11 offset:800
  s_waitcnt lgkmcnt(12)
  v_mfma_f32_32x32x16_bf16 v[160:175], v[124:127], v[148:151], v[160:175]
  ds_read_b64_tr_b16 v[120:121], v15 offset:43008
  ds_read_b64_tr_b16 v[122:123], v15 offset:43232
  ds_read_b128 v[144:147], v11 offset:832
  s_waitcnt lgkmcnt(12)
  v_mfma_f32_32x32x16_bf16 v[160:175], v[128:131], v[152:155], v[160:175]
  ds_read_b64_tr_b16 v[124:125], v15 offset:46592
  ds_read_b64_tr_b16 v[126:127], v15 offset:46816
  ds_read_b128 v[148:151], v11 offset:864
  s_waitcnt lgkmcnt(12)
  v_mfma_f32_32x32x16_bf16 v[160:175], v[132:135], v[156:159], v[160:175]
  ds_read_b128 v[54:57], v38
  ds_read_b128 v[58:61], v38 offset:256
  s_waitcnt lgkmcnt(11)
  v_mfma_f32_32x32x16_bf16 v[160:175], v[112:115], v[136:139], v[160:175]
  s_waitcnt lgkmcnt(8)
  v_mfma_f32_32x32x16_bf16 v[160:175], v[116:119], v[140:143], v[160:175]
  s_waitcnt lgkmcnt(5)
  v_mfma_f32_32x32x16_bf16 v[160:175], v[120:123], v[144:147], v[160:175]
  s_waitcnt lgkmcnt(2)
  v_mfma_f32_32x32x16_bf16 v[160:175], v[124:127], v[148:151], v[160:175]
  v_mov_b32 v224, 0
  v_mov_b32 v225, 0
  v_mov_b32 v226, 0
  v_mov_b32 v227, 0
  v_mov_b32 v228, 0
  v_mov_b32 v229, 0
  v_mov_b32 v230, 0
  v_mov_b32 v231, 0
  v_mov_b32 v232, 0
  v_mov_b32 v233, 0
  v_mov_b32 v234, 0
  v_mov_b32 v235, 0
  v_mov_b32 v236, 0
  v_mov_b32 v237, 0
  v_pk_mul_f32 v[160:161], v[160:161], s[74:75]
  v_pk_mul_f32 v[162:163], v[162:163], s[74:75]
  v_pk_mul_f32 v[164:165], v[164:165], s[74:75]
  v_pk_mul_f32 v[166:167], v[166:167], s[74:75]
  v_pk_mul_f32 v[168:169], v[168:169], s[74:75]
  v_pk_mul_f32 v[170:171], v[170:171], s[74:75]
  v_pk_mul_f32 v[172:173], v[172:173], s[74:75]
  v_pk_mul_f32 v[174:175], v[174:175], s[74:75]
  v_cvt_pk_bf16_f32 v184, v160, v161
  v_cvt_pk_bf16_f32 v185, v162, v163
  v_cvt_pk_bf16_f32 v186, v164, v165
  v_cvt_pk_bf16_f32 v187, v166, v167
  v_cvt_pk_bf16_f32 v188, v168, v169
  v_cvt_pk_bf16_f32 v189, v170, v171
  v_cvt_pk_bf16_f32 v190, v172, v173
  v_cvt_pk_bf16_f32 v191, v174, v175
  s_mov_b32 exec_lo, 0
  v_mov_b32 v190, 0
  v_mov_b32 v191, 0
  s_mov_b64 exec, -1
  s_waitcnt lgkmcnt(1)
  v_mfma_f32_32x32x16_bf16 v[160:175], v[54:57], v[184:187], 0
  ds_write_b128 v39, v[184:187]
  s_waitcnt lgkmcnt(1)
  v_mfma_f32_32x32x16_bf16 v[160:175], v[58:61], v[188:191], v[160:175]
  v_mov_b32 v238, 0
  v_mov_b32 v239, 0
  v_mov_b32 v240, 0
  v_mov_b32 v241, 0
  v_mov_b32 v242, 0
  v_mov_b32 v243, 0
  v_mov_b32 v244, 0
  v_mov_b32 v245, 0
  v_mov_b32 v246, 0
  v_mov_b32 v247, 0
  v_mov_b32 v248, 0
  v_mov_b32 v249, 0
  v_mov_b32 v250, 0
  v_mov_b32 v251, 0
  v_mov_b32 v252, 0
  v_mov_b32 v253, 0
  v_max3_f32 v6, v160, v161, v162
  v_max_f32 v6, v6, v163
  v_mov_b32 v7, v6
  v_mov_b32 v254, 0
  v_mov_b32 v255, 0
  v_permlane32_swap_b32 v6, v7
  v_max_f32 v6, v6, v7
  v_sub_f32 v6, 0xc2200000, v6
  s_mov_b32 exec_lo, 0
  v_cvt_pk_bf16_f32 v190, v6, 0
  s_mov_b64 exec, -1
  ds_write_b128 v39, v[188:191] offset:1024
  buffer_load_dword v52, v51, s[24:27], s79 offen sc1
  s_waitcnt lgkmcnt(0)
  s_barrier
  ds_read_b128 v[160:163], v48
  ds_read_b128 v[164:167], v48 offset:1024
  ds_read_b128 v[168:171], v49
  ds_read_b128 v[172:175], v49 offset:1024
  ds_read_b128 v[176:179], v50
  ds_read_b128 v[180:183], v50 offset:1024
  v_mov_b32 v94, 0
  v_mov_b32 v95, 0
  v_mov_b32 v16, 0
  v_mov_b32 v17, 0
  v_mov_b32 v18, 0
  v_mov_b32 v19, 0
  v_mov_b32 v156, 0
  v_mov_b32 v157, 0
  v_mov_b32 v158, 0
  v_mov_b32 v159, 0
  s_lshl2_add_u32 s69, s56, s52
  s_mul_i32 s64, s69, 114688
  s_lshr_b32 s65, s57, 2
  s_mul_i32 s65, s65, 28672
  s_add_u32 s64, s64, s65
  s_add_u32 s64, s64, 10485760
  s_lshl_b32 s65, s55, 12
  s_add_u32 s74, s64, s65
  s_lshl_b32 s65, s55, 10
  s_add_u32 s65, s65, 16384
  s_add_u32 s75, s64, s65
  s_add_u32 s76, s75, 4096
  s_add_u32 s77, s75, 8192
Lpoll_3:
  s_waitcnt vmcnt(0)
  v_xor_b32 v6, v3, v52
  v_cmp_lt_u32 vcc, 15, v6
  s_sub_u32 s59, s59, 1
  s_cbranch_vccz Lpdone_4
  s_cmp_lt_i32 s59, 0
  s_cbranch_scc1 Lpdone_4
  s_mov_b64 exec, vcc
  buffer_load_dword v52, v51, s[24:27], s79 offen sc1
  s_mov_b64 exec, -1
  s_branch Lpoll_3
Lpdone_4:
  buffer_load_dwordx4 v[96:99], v40, s[24:27], s72 offen offset:0 sc1
  buffer_load_dwordx4 v[100:103], v40, s[24:27], s72 offen offset:1024 sc1
  buffer_load_dwordx4 v[104:107], v40, s[24:27], s72 offen offset:2048 sc1
  buffer_load_dwordx4 v[108:111], v40, s[24:27], s72 offen offset:3072 sc1
  buffer_load_dwordx4 v[112:115], v41, s[24:27], s72 offen offset:0 sc1
  buffer_load_dwordx4 v[116:119], v41, s[24:27], s72 offen offset:1024 sc1
  buffer_load_dwordx4 v[120:123], v41, s[24:27], s72 offen offset:2048 sc1
  buffer_load_dwordx4 v[124:127], v41, s[24:27], s72 offen offset:3072 sc1
  buffer_load_dwordx4 v[128:131], v42, s[24:27], s72 offen offset:0 sc1
  buffer_load_dwordx4 v[132:135], v42, s[24:27], s72 offen offset:1024 sc1
  buffer_load_dwordx4 v[136:139], v42, s[24:27], s72 offen offset:2048 sc1
  buffer_load_dwordx4 v[140:143], v42, s[24:27], s72 offen offset:3072 sc1
  buffer_load_dwordx4 v[144:147], v43, s[24:27], s72 offen offset:0 sc1
  buffer_load_dwordx4 v[148:151], v43, s[24:27], s72 offen offset:1024 sc1
  v_mov_b32 v7, 162816
  s_lshr_b32 s64, s56, 2
  s_cmp_lg_u32 s64, s52
  s_cbranch_scc1 Lnoloc_5
  v_cmp_ne_u32 vcc, s60, v6
  s_and_b32 s64, s56, 3
  s_lshl_b32 s64, s64, 4
  s_lshr_b64 vcc, vcc, s64
  s_and_b32 s64, vcc_lo, 0xffff
  s_cselect_b32 s64, 0, 1
  v_mov_b32 v6, s64
  ds_write_b32 v7, v6
Lnoloc_5:
  s_waitcnt lgkmcnt(0)
  s_barrier
  ds_read_b32 v10, v7
  s_setprio 2
  s_waitcnt vmcnt(13)
  v_mfma_f32_32x32x16_bf16 v[64:79], v[96:99], v[160:163], 0
  s_waitcnt vmcnt(12)
  v_mfma_f32_32x32x16_bf16 v[64:79], v[100:103], v[164:167], v[64:79]
  s_nop 7
  s_nop 2
  s_branch Lmid
.p2align 6
Ltop:
  v_exp_f32 v64, v64
  v_cvt_pk_bf16_f32 v19, v94, v95
  v_exp_f32 v65, v65
  v_exp_f32 v66, v66
  v_mfma_f32_32x32x16_bf16 v[208:223], v[108:111], v[16:19], v[208:223]
  v_exp_f32 v67, v67
  v_cvt_pk_bf16_f32 v12, v64, v65
  v_exp_f32 v68, v68
  v_cvt_pk_bf16_f32 v13, v66, v67
  v_exp_f32 v69, v69
  v_mfma_f32_32x32x16_bf16 v[80:95], v[96:99], v[184:187], 0
  v_exp_f32 v70, v70
  v_cvt_pk_bf16_f32 v14, v68, v69
  v_exp_f32 v71, v71
  v_exp_f32 v72, v72
  v_cvt_pk_bf16_f32 v15, v70, v71
  v_mfma_f32_32x32x16_bf16 v[80:95], v[100:103], v[188:191], v[80:95]
  buffer_load_dwordx4 v[96:99], v40, s[24:27], s72 offen offset:0 sc1
  v_exp_f32 v73, v73
  v_exp_f32 v74, v74
  v_cvt_pk_bf16_f32 v16, v72, v73
  v_exp_f32 v75, v75
  v_exp_f32 v76, v76
  v_cvt_pk_bf16_f32 v17, v74, v75
  v_mfma_f32_32x32x16_bf16 v[224:239], v[104:107], v[12:15], v[224:239]
  v_exp_f32 v77, v77
  v_exp_f32 v78, v78
  v_cvt_pk_bf16_f32 v18, v76, v77
  v_exp_f32 v79, v79
  v_exp_f32 v80, v80
  v_cvt_pk_bf16_f32 v19, v78, v79
  v_exp_f32 v81, v81
  v_exp_f32 v82, v82
  v_mfma_f32_32x32x16_bf16 v[224:239], v[108:111], v[16:19], v[224:239]
  v_exp_f32 v83, v83
  v_cvt_pk_bf16_f32 v12, v80, v81
  v_exp_f32 v84, v84
  v_cvt_pk_bf16_f32 v13, v82, v83
  v_exp_f32 v85, v85
  s_waitcnt vmcnt(12)
  v_mfma_f32_32x32x16_bf16 v[64:79], v[112:115], v[160:163], 0
  v_exp_f32 v86, v86
  v_cvt_pk_bf16_f32 v14, v84, v85
  v_exp_f32 v87, v87
  v_exp_f32 v88, v88
  v_cvt_pk_bf16_f32 v15, v86, v87
  s_waitcnt vmcnt(11)
  v_mfma_f32_32x32x16_bf16 v[64:79], v[116:119], v[164:167], v[64:79]
  buffer_load_dwordx4 v[100:103], v40, s[24:27], s72 offen offset:1024 sc1
  v_exp_f32 v89, v89
  v_exp_f32 v90, v90
  v_cvt_pk_bf16_f32 v16, v88, v89
  v_exp_f32 v91, v91
  v_exp_f32 v92, v92
  v_cvt_pk_bf16_f32 v17, v90, v91
  v_mfma_f32_32x32x16_bf16 v[240:255], v[104:107], v[12:15], v[240:255]
  v_exp_f32 v93, v93
  v_exp_f32 v94, v94
  v_cvt_pk_bf16_f32 v18, v92, v93
  v_exp_f32 v95, v95
  v_exp_f32 v64, v64
  v_cvt_pk_bf16_f32 v19, v94, v95
  v_exp_f32 v65, v65
  v_exp_f32 v66, v66
  v_mfma_f32_32x32x16_bf16 v[240:255], v[108:111], v[16:19], v[240:255]
  v_exp_f32 v67, v67
  v_cvt_pk_bf16_f32 v12, v64, v65
  v_exp_f32 v68, v68
  v_cvt_pk_bf16_f32 v13, v66, v67
  v_exp_f32 v69, v69
  v_mfma_f32_32x32x16_bf16 v[80:95], v[112:115], v[168:171], 0
  v_exp_f32 v70, v70
  v_cvt_pk_bf16_f32 v14, v68, v69
  v_exp_f32 v71, v71
  v_exp_f32 v72, v72
  v_cvt_pk_bf16_f32 v15, v70, v71
  v_mfma_f32_32x32x16_bf16 v[80:95], v[116:119], v[172:175], v[80:95]
  buffer_load_dwordx4 v[104:107], v40, s[24:27], s72 offen offset:2048 sc1
  v_exp_f32 v73, v73
  v_exp_f32 v74, v74
  v_cvt_pk_bf16_f32 v16, v72, v73
  v_exp_f32 v75, v75
  v_exp_f32 v76, v76
  v_cvt_pk_bf16_f32 v17, v74, v75
  s_waitcnt vmcnt(12)
  v_mfma_f32_32x32x16_bf16 v[192:207], v[120:123], v[12:15], v[192:207]
  v_exp_f32 v77, v77
  v_exp_f32 v78, v78
  v_cvt_pk_bf16_f32 v18, v76, v77
  v_exp_f32 v79, v79
  v_exp_f32 v80, v80
  v_cvt_pk_bf16_f32 v19, v78, v79
  v_exp_f32 v81, v81
  v_exp_f32 v82, v82
  s_waitcnt vmcnt(11)
  v_mfma_f32_32x32x16_bf16 v[192:207], v[124:127], v[16:19], v[192:207]
  v_exp_f32 v83, v83
  v_cvt_pk_bf16_f32 v12, v80, v81
  v_exp_f32 v84, v84
  v_cvt_pk_bf16_f32 v13, v82, v83
  v_exp_f32 v85, v85
  v_mfma_f32_32x32x16_bf16 v[64:79], v[112:115], v[176:179], 0
  v_exp_f32 v86, v86
  v_cvt_pk_bf16_f32 v14, v84, v85
  v_exp_f32 v87, v87
  v_exp_f32 v88, v88
  v_cvt_pk_bf16_f32 v15, v86, v87
  v_mfma_f32_32x32x16_bf16 v[64:79], v[116:119], v[180:183], v[64:79]
  buffer_load_dwordx4 v[108:111], v40, s[24:27], s72 offen offset:3072 sc1
  v_exp_f32 v89, v89
  v_exp_f32 v90, v90
  v_cvt_pk_bf16_f32 v16, v88, v89
  v_exp_f32 v91, v91
  v_exp_f32 v92, v92
  v_cvt_pk_bf16_f32 v17, v90, v91
  v_mfma_f32_32x32x16_bf16 v[208:223], v[120:123], v[12:15], v[208:223]
  v_exp_f32 v93, v93
  v_exp_f32 v94, v94
  v_cvt_pk_bf16_f32 v18, v92, v93
  v_exp_f32 v95, v95
  v_exp_f32 v64, v64
  v_cvt_pk_bf16_f32 v19, v94, v95
  v_exp_f32 v65, v65
  v_exp_f32 v66, v66
  v_mfma_f32_32x32x16_bf16 v[208:223], v[124:127], v[16:19], v[208:223]
  v_exp_f32 v67, v67
  v_cvt_pk_bf16_f32 v12, v64, v65
  v_exp_f32 v68, v68
  v_cvt_pk_bf16_f32 v13, v66, v67
  v_exp_f32 v69, v69
  v_mfma_f32_32x32x16_bf16 v[80:95], v[112:115], v[184:187], 0
  v_exp_f32 v70, v70
  v_cvt_pk_bf16_f32 v14, v68, v69
  v_exp_f32 v71, v71
  v_exp_f32 v72, v72
  v_cvt_pk_bf16_f32 v15, v70, v71
  v_mfma_f32_32x32x16_bf16 v[80:95], v[116:119], v[188:191], v[80:95]
  buffer_load_dwordx4 v[112:115], v41, s[24:27], s72 offen offset:0 sc1
  v_exp_f32 v73, v73
  v_exp_f32 v74, v74
  v_cvt_pk_bf16_f32 v16, v72, v73
  v_exp_f32 v75, v75
  v_exp_f32 v76, v76
  v_cvt_pk_bf16_f32 v17, v74, v75
  v_mfma_f32_32x32x16_bf16 v[224:239], v[120:123], v[12:15], v[224:239]
  v_exp_f32 v77, v77
  v_exp_f32 v78, v78
  v_cvt_pk_bf16_f32 v18, v76, v77
  v_exp_f32 v79, v79
  v_exp_f32 v80, v80
  v_cvt_pk_bf16_f32 v19, v78, v79
  v_exp_f32 v81, v81
  v_exp_f32 v82, v82
  v_mfma_f32_32x32x16_bf16 v[224:239], v[124:127], v[16:19], v[224:239]
  v_exp_f32 v83, v83
  v_cvt_pk_bf16_f32 v12, v80, v81
  v_exp_f32 v84, v84
  v_cvt_pk_bf16_f32 v13, v82, v83
  v_exp_f32 v85, v85
  s_waitcnt vmcnt(12)
  v_mfma_f32_32x32x16_bf16 v[64:79], v[128:131], v[160:163], 0
  v_exp_f32 v86, v86
  v_cvt_pk_bf16_f32 v14, v84, v85
  v_exp_f32 v87, v87
  v_exp_f32 v88, v88
  v_cvt_pk_bf16_f32 v15, v86, v87
  s_waitcnt vmcnt(11)
  v_mfma_f32_32x32x16_bf16 v[64:79], v[132:135], v[164:167], v[64:79]
  buffer_load_dwordx4 v[116:119], v41, s[24:27], s72 offen offset:1024 sc1
  v_exp_f32 v89, v89
  v_exp_f32 v90, v90
  v_cvt_pk_bf16_f32 v16, v88, v89
  v_exp_f32 v91, v91
  v_exp_f32 v92, v92
  v_cvt_pk_bf16_f32 v17, v90, v91
  v_mfma_f32_32x32x16_bf16 v[240:255], v[120:123], v[12:15], v[240:255]
  v_exp_f32 v93, v93
  v_exp_f32 v94, v94
  v_cvt_pk_bf16_f32 v18, v92, v93
  v_exp_f32 v95, v95
  v_exp_f32 v64, v64
  v_cvt_pk_bf16_f32 v19, v94, v95
  v_exp_f32 v65, v65
  v_exp_f32 v66, v66
  v_mfma_f32_32x32x16_bf16 v[240:255], v[124:127], v[16:19], v[240:255]
  v_exp_f32 v67, v67
  v_cvt_pk_bf16_f32 v12, v64, v65
  v_exp_f32 v68, v68
  v_cvt_pk_bf16_f32 v13, v66, v67
  v_exp_f32 v69, v69
  v_mfma_f32_32x32x16_bf16 v[80:95], v[128:131], v[168:171], 0
  v_exp_f32 v70, v70
  v_cvt_pk_bf16_f32 v14, v68, v69
  v_exp_f32 v71, v71
  v_exp_f32 v72, v72
  v_cvt_pk_bf16_f32 v15, v70, v71
  v_mfma_f32_32x32x16_bf16 v[80:95], v[132:135], v[172:175], v[80:95]
  buffer_load_dwordx4 v[120:123], v41, s[24:27], s72 offen offset:2048 sc1
  v_exp_f32 v73, v73
  v_exp_f32 v74, v74
  v_cvt_pk_bf16_f32 v16, v72, v73
  v_exp_f32 v75, v75
  v_exp_f32 v76, v76
  v_cvt_pk_bf16_f32 v17, v74, v75
  s_waitcnt vmcnt(12)
  v_mfma_f32_32x32x16_bf16 v[192:207], v[136:139], v[12:15], v[192:207]
  v_exp_f32 v77, v77
  v_exp_f32 v78, v78
  v_cvt_pk_bf16_f32 v18, v76, v77
  v_exp_f32 v79, v79
  v_exp_f32 v80, v80
  v_cvt_pk_bf16_f32 v19, v78, v79
  v_exp_f32 v81, v81
  v_exp_f32 v82, v82
  s_waitcnt vmcnt(11)
  v_mfma_f32_32x32x16_bf16 v[192:207], v[140:143], v[16:19], v[192:207]
  v_exp_f32 v83, v83
  v_cvt_pk_bf16_f32 v12, v80, v81
  v_exp_f32 v84, v84
  v_cvt_pk_bf16_f32 v13, v82, v83
  v_exp_f32 v85, v85
  v_mfma_f32_32x32x16_bf16 v[64:79], v[128:131], v[176:179], 0
  v_exp_f32 v86, v86
  v_cvt_pk_bf16_f32 v14, v84, v85
  v_exp_f32 v87, v87
  v_exp_f32 v88, v88
  v_cvt_pk_bf16_f32 v15, v86, v87
  v_mfma_f32_32x32x16_bf16 v[64:79], v[132:135], v[180:183], v[64:79]
  buffer_load_dwordx4 v[124:127], v41, s[24:27], s72 offen offset:3072 sc1
  v_exp_f32 v89, v89
  v_exp_f32 v90, v90
  v_cvt_pk_bf16_f32 v16, v88, v89
  v_exp_f32 v91, v91
  v_exp_f32 v92, v92
  v_cvt_pk_bf16_f32 v17, v90, v91
  v_mfma_f32_32x32x16_bf16 v[208:223], v[136:139], v[12:15], v[208:223]
  v_exp_f32 v93, v93
  v_exp_f32 v94, v94
  v_cvt_pk_bf16_f32 v18, v92, v93
  v_exp_f32 v95, v95
  v_exp_f32 v64, v64
  v_cvt_pk_bf16_f32 v19, v94, v95
  v_exp_f32 v65, v65
  v_exp_f32 v66, v66
  v_mfma_f32_32x32x16_bf16 v[208:223], v[140:143], v[16:19], v[208:223]
  v_exp_f32 v67, v67
  v_cvt_pk_bf16_f32 v12, v64, v65
  v_exp_f32 v68, v68
  v_cvt_pk_bf16_f32 v13, v66, v67
  v_exp_f32 v69, v69
  v_mfma_f32_32x32x16_bf16 v[80:95], v[128:131], v[184:187], 0
  v_exp_f32 v70, v70
  v_cvt_pk_bf16_f32 v14, v68, v69
  v_exp_f32 v71, v71
  v_exp_f32 v72, v72
  v_cvt_pk_bf16_f32 v15, v70, v71
  v_mfma_f32_32x32x16_bf16 v[80:95], v[132:135], v[188:191], v[80:95]
  buffer_load_dwordx4 v[128:131], v42, s[24:27], s72 offen offset:0 sc1
  v_exp_f32 v73, v73
  v_exp_f32 v74, v74
  v_cvt_pk_bf16_f32 v16, v72, v73
  v_exp_f32 v75, v75
  v_exp_f32 v76, v76
  v_cvt_pk_bf16_f32 v17, v74, v75
  v_mfma_f32_32x32x16_bf16 v[224:239], v[136:139], v[12:15], v[224:239]
  v_exp_f32 v77, v77
  v_exp_f32 v78, v78
  v_cvt_pk_bf16_f32 v18, v76, v77
  v_exp_f32 v79, v79
  v_exp_f32 v80, v80
  v_cvt_pk_bf16_f32 v19, v78, v79
  v_exp_f32 v81, v81
  v_exp_f32 v82, v82
  v_mfma_f32_32x32x16_bf16 v[224:239], v[140:143], v[16:19], v[224:239]
  v_exp_f32 v83, v83
  v_cvt_pk_bf16_f32 v12, v80, v81
  v_exp_f32 v84, v84
  v_cvt_pk_bf16_f32 v13, v82, v83
  v_exp_f32 v85, v85
  s_waitcnt vmcnt(12)
  v_mfma_f32_32x32x16_bf16 v[64:79], v[144:147], v[160:163], 0
  v_exp_f32 v86, v86
  v_cvt_pk_bf16_f32 v14, v84, v85
  v_exp_f32 v87, v87
  v_exp_f32 v88, v88
  v_cvt_pk_bf16_f32 v15, v86, v87
  s_waitcnt vmcnt(11)
  v_mfma_f32_32x32x16_bf16 v[64:79], v[148:151], v[164:167], v[64:79]
  buffer_load_dwordx4 v[132:135], v42, s[24:27], s72 offen offset:1024 sc1
  v_exp_f32 v89, v89
  v_exp_f32 v90, v90
  v_cvt_pk_bf16_f32 v16, v88, v89
  v_exp_f32 v91, v91
  v_exp_f32 v92, v92
  v_cvt_pk_bf16_f32 v17, v90, v91
  v_mfma_f32_32x32x16_bf16 v[240:255], v[136:139], v[12:15], v[240:255]
  v_exp_f32 v93, v93
  v_exp_f32 v94, v94
  v_cvt_pk_bf16_f32 v18, v92, v93
  v_exp_f32 v95, v95
  v_exp_f32 v64, v64
  v_cvt_pk_bf16_f32 v19, v94, v95
  v_exp_f32 v65, v65
  v_exp_f32 v66, v66
  v_mfma_f32_32x32x16_bf16 v[240:255], v[140:143], v[16:19], v[240:255]
  v_exp_f32 v67, v67
  v_cvt_pk_bf16_f32 v12, v64, v65
  v_exp_f32 v68, v68
  v_cvt_pk_bf16_f32 v13, v66, v67
  v_exp_f32 v69, v69
  v_mfma_f32_32x32x16_bf16 v[80:95], v[144:147], v[168:171], 0
  v_exp_f32 v70, v70
  v_cvt_pk_bf16_f32 v14, v68, v69
  v_exp_f32 v71, v71
  v_exp_f32 v72, v72
  v_cvt_pk_bf16_f32 v15, v70, v71
  v_mfma_f32_32x32x16_bf16 v[80:95], v[148:151], v[172:175], v[80:95]
  buffer_load_dwordx4 v[136:139], v42, s[24:27], s72 offen offset:2048 sc1
  v_exp_f32 v73, v73
  v_exp_f32 v74, v74
  v_cvt_pk_bf16_f32 v16, v72, v73
  v_exp_f32 v75, v75
  v_exp_f32 v76, v76
  v_cvt_pk_bf16_f32 v17, v74, v75
  s_waitcnt vmcnt(12)
  v_mfma_f32_32x32x16_bf16 v[192:207], v[152:155], v[12:15], v[192:207]
  v_exp_f32 v77, v77
  v_exp_f32 v78, v78
  v_cvt_pk_bf16_f32 v18, v76, v77
  v_exp_f32 v79, v79
  v_exp_f32 v80, v80
  v_cvt_pk_bf16_f32 v19, v78, v79
  v_exp_f32 v81, v81
  v_exp_f32 v82, v82
  s_waitcnt vmcnt(11)
  v_mfma_f32_32x32x16_bf16 v[192:207], v[156:159], v[16:19], v[192:207]
  v_exp_f32 v83, v83
  v_cvt_pk_bf16_f32 v12, v80, v81
  v_exp_f32 v84, v84
  v_cvt_pk_bf16_f32 v13, v82, v83
  v_exp_f32 v85, v85
  v_mfma_f32_32x32x16_bf16 v[64:79], v[144:147], v[176:179], 0
  v_exp_f32 v86, v86
  v_cvt_pk_bf16_f32 v14, v84, v85
  v_exp_f32 v87, v87
  v_exp_f32 v88, v88
  v_cvt_pk_bf16_f32 v15, v86, v87
  v_mfma_f32_32x32x16_bf16 v[64:79], v[148:151], v[180:183], v[64:79]
  buffer_load_dwordx4 v[140:143], v42, s[24:27], s72 offen offset:3072 sc1
  v_exp_f32 v89, v89
  v_exp_f32 v90, v90
  v_cvt_pk_bf16_f32 v16, v88, v89
  v_exp_f32 v91, v91
  v_exp_f32 v92, v92
  v_cvt_pk_bf16_f32 v17, v90, v91
  v_mfma_f32_32x32x16_bf16 v[208:223], v[152:155], v[12:15], v[208:223]
  v_exp_f32 v93, v93
  v_exp_f32 v94, v94
  v_cvt_pk_bf16_f32 v18, v92, v93
  v_exp_f32 v95, v95
  v_exp_f32 v64, v64
  v_cvt_pk_bf16_f32 v19, v94, v95
  v_exp_f32 v65, v65
  v_exp_f32 v66, v66
  v_mfma_f32_32x32x16_bf16 v[208:223], v[156:159], v[16:19], v[208:223]
  v_exp_f32 v67, v67
  v_cvt_pk_bf16_f32 v12, v64, v65
  v_exp_f32 v68, v68
  v_cvt_pk_bf16_f32 v13, v66, v67
  v_exp_f32 v69, v69
  v_mfma_f32_32x32x16_bf16 v[80:95], v[144:147], v[184:187], 0
  v_exp_f32 v70, v70
  v_cvt_pk_bf16_f32 v14, v68, v69
  v_exp_f32 v71, v71
  v_exp_f32 v72, v72
  v_cvt_pk_bf16_f32 v15, v70, v71
  v_mfma_f32_32x32x16_bf16 v[80:95], v[148:151], v[188:191], v[80:95]
  buffer_load_dwordx4 v[144:147], v43, s[24:27], s72 offen offset:0 sc1
  v_exp_f32 v73, v73
  v_exp_f32 v74, v74
  v_cvt_pk_bf16_f32 v16, v72, v73
  v_exp_f32 v75, v75
  v_exp_f32 v76, v76
  v_cvt_pk_bf16_f32 v17, v74, v75
  v_mfma_f32_32x32x16_bf16 v[224:239], v[152:155], v[12:15], v[224:239]
  v_exp_f32 v77, v77
  v_exp_f32 v78, v78
  v_cvt_pk_bf16_f32 v18, v76, v77
  v_exp_f32 v79, v79
  v_exp_f32 v80, v80
  v_cvt_pk_bf16_f32 v19, v78, v79
  v_exp_f32 v81, v81
  v_exp_f32 v82, v82
  v_mfma_f32_32x32x16_bf16 v[224:239], v[156:159], v[16:19], v[224:239]
  v_exp_f32 v83, v83
  v_cvt_pk_bf16_f32 v12, v80, v81
  v_exp_f32 v84, v84
  v_cvt_pk_bf16_f32 v13, v82, v83
  v_exp_f32 v85, v85
  s_waitcnt vmcnt(12)
  v_mfma_f32_32x32x16_bf16 v[64:79], v[96:99], v[160:163], 0
  v_exp_f32 v86, v86
  v_cvt_pk_bf16_f32 v14, v84, v85
  v_exp_f32 v87, v87
  v_exp_f32 v88, v88
  v_cvt_pk_bf16_f32 v15, v86, v87
  s_waitcnt vmcnt(11)
  v_mfma_f32_32x32x16_bf16 v[64:79], v[100:103], v[164:167], v[64:79]
  buffer_load_dwordx4 v[148:151], v43, s[24:27], s72 offen offset:1024 sc1
  v_exp_f32 v89, v89
  v_exp_f32 v90, v90
  v_cvt_pk_bf16_f32 v16, v88, v89
  v_exp_f32 v91, v91
  v_exp_f32 v92, v92
  v_cvt_pk_bf16_f32 v17, v90, v91
  v_mfma_f32_32x32x16_bf16 v[240:255], v[152:155], v[12:15], v[240:255]
  v_exp_f32 v93, v93
  v_exp_f32 v94, v94
  v_cvt_pk_bf16_f32 v18, v92, v93
  v_exp_f32 v95, v95
Lmid:
  v_exp_f32 v64, v64
  v_cvt_pk_bf16_f32 v19, v94, v95
  v_exp_f32 v65, v65
  v_exp_f32 v66, v66
  v_mfma_f32_32x32x16_bf16 v[240:255], v[156:159], v[16:19], v[240:255]
  v_exp_f32 v67, v67
  v_cvt_pk_bf16_f32 v12, v64, v65
  v_exp_f32 v68, v68
  v_cvt_pk_bf16_f32 v13, v66, v67
  v_exp_f32 v69, v69
  v_mfma_f32_32x32x16_bf16 v[80:95], v[96:99], v[168:171], 0
  v_exp_f32 v70, v70
  v_cvt_pk_bf16_f32 v14, v68, v69
  v_exp_f32 v71, v71
  v_exp_f32 v72, v72
  v_cvt_pk_bf16_f32 v15, v70, v71
  v_mfma_f32_32x32x16_bf16 v[80:95], v[100:103], v[172:175], v[80:95]
  buffer_load_dwordx4 v[152:155], v43, s[24:27], s72 offen offset:2048 sc1
  v_exp_f32 v73, v73
  v_exp_f32 v74, v74
  v_cvt_pk_bf16_f32 v16, v72, v73
  v_exp_f32 v75, v75
  v_exp_f32 v76, v76
  v_cvt_pk_bf16_f32 v17, v74, v75
  s_waitcnt vmcnt(12)
  v_mfma_f32_32x32x16_bf16 v[192:207], v[104:107], v[12:15], v[192:207]
  v_exp_f32 v77, v77
  v_exp_f32 v78, v78
  v_cvt_pk_bf16_f32 v18, v76, v77
  v_exp_f32 v79, v79
  v_exp_f32 v80, v80
  v_cvt_pk_bf16_f32 v19, v78, v79
  v_exp_f32 v81, v81
  v_exp_f32 v82, v82
  s_waitcnt vmcnt(11)
  v_mfma_f32_32x32x16_bf16 v[192:207], v[108:111], v[16:19], v[192:207]
  v_exp_f32 v83, v83
  v_cvt_pk_bf16_f32 v12, v80, v81
  v_exp_f32 v84, v84
  v_cvt_pk_bf16_f32 v13, v82, v83
  v_exp_f32 v85, v85
  v_mfma_f32_32x32x16_bf16 v[64:79], v[96:99], v[176:179], 0
  v_exp_f32 v86, v86
  v_cvt_pk_bf16_f32 v14, v84, v85
  v_exp_f32 v87, v87
  v_exp_f32 v88, v88
  v_cvt_pk_bf16_f32 v15, v86, v87
  v_mfma_f32_32x32x16_bf16 v[64:79], v[100:103], v[180:183], v[64:79]
  buffer_load_dwordx4 v[156:159], v43, s[24:27], s72 offen offset:3072 sc1
  v_exp_f32 v89, v89
  v_exp_f32 v90, v90
  v_cvt_pk_bf16_f32 v16, v88, v89
  v_exp_f32 v91, v91
  v_exp_f32 v92, v92
  v_cvt_pk_bf16_f32 v17, v90, v91
  v_mfma_f32_32x32x16_bf16 v[208:223], v[104:107], v[12:15], v[208:223]
  s_add_u32 s72, s72, 16384
  s_cmp_lt_u32 s72, s73
  v_exp_f32 v93, v93
  v_exp_f32 v94, v94
  v_cvt_pk_bf16_f32 v18, v92, v93
  v_exp_f32 v95, v95
  s_cbranch_scc1 Ltop
  s_waitcnt lgkmcnt(0)
  v_readfirstlane_b32 s61, v10
  v_exp_f32 v64, v64
  s_barrier
  v_cvt_pk_bf16_f32 v19, v94, v95
  v_exp_f32 v65, v65
  v_exp_f32 v66, v66
  v_mfma_f32_32x32x16_bf16 v[208:223], v[108:111], v[16:19], v[208:223]
  v_exp_f32 v67, v67
  v_cvt_pk_bf16_f32 v12, v64, v65
  v_exp_f32 v68, v68
  v_cvt_pk_bf16_f32 v13, v66, v67
  v_exp_f32 v69, v69
  v_mfma_f32_32x32x16_bf16 v[80:95], v[96:99], v[184:187], 0
  v_exp_f32 v70, v70
  v_cvt_pk_bf16_f32 v14, v68, v69
  v_exp_f32 v71, v71
  v_exp_f32 v72, v72
  v_cvt_pk_bf16_f32 v15, v70, v71
  v_mfma_f32_32x32x16_bf16 v[80:95], v[100:103], v[188:191], v[80:95]
  v_exp_f32 v73, v73
  v_exp_f32 v74, v74
  v_cvt_pk_bf16_f32 v16, v72, v73
  v_exp_f32 v75, v75
  v_exp_f32 v76, v76
  v_cvt_pk_bf16_f32 v17, v74, v75
  v_mfma_f32_32x32x16_bf16 v[224:239], v[104:107], v[12:15], v[224:239]
  v_exp_f32 v77, v77
  v_exp_f32 v78, v78
  v_cvt_pk_bf16_f32 v18, v76, v77
  v_exp_f32 v79, v79
  s_nop 0
  v_exp_f32 v80, v80
  v_cvt_pk_bf16_f32 v19, v78, v79
  v_exp_f32 v81, v81
  v_exp_f32 v82, v82
  v_mfma_f32_32x32x16_bf16 v[224:239], v[108:111], v[16:19], v[224:239]
  v_exp_f32 v83, v83
  v_cvt_pk_bf16_f32 v12, v80, v81
  v_exp_f32 v84, v84
  v_cvt_pk_bf16_f32 v13, v82, v83
  v_exp_f32 v85, v85
  s_waitcnt vmcnt(11)
  v_mfma_f32_32x32x16_bf16 v[64:79], v[112:115], v[160:163], 0
  v_exp_f32 v86, v86
  v_cvt_pk_bf16_f32 v14, v84, v85
  v_exp_f32 v87, v87
  v_exp_f32 v88, v88
  v_cvt_pk_bf16_f32 v15, v86, v87
  s_waitcnt vmcnt(10)
  v_mfma_f32_32x32x16_bf16 v[64:79], v[116:119], v[164:167], v[64:79]
  v_exp_f32 v89, v89
  v_exp_f32 v90, v90
  v_cvt_pk_bf16_f32 v16, v88, v89
  v_exp_f32 v91, v91
  v_exp_f32 v92, v92
  v_cvt_pk_bf16_f32 v17, v90, v91
  v_mfma_f32_32x32x16_bf16 v[240:255], v[104:107], v[12:15], v[240:255]
  v_exp_f32 v93, v93
  v_exp_f32 v94, v94
  v_cvt_pk_bf16_f32 v18, v92, v93
  v_exp_f32 v95, v95
  s_nop 0
  v_exp_f32 v64, v64
  v_cvt_pk_bf16_f32 v19, v94, v95
  v_exp_f32 v65, v65
  v_exp_f32 v66, v66
  v_mfma_f32_32x32x16_bf16 v[240:255], v[108:111], v[16:19], v[240:255]
  v_exp_f32 v67, v67
  v_cvt_pk_bf16_f32 v12, v64, v65
  v_exp_f32 v68, v68
  v_cvt_pk_bf16_f32 v13, v66, v67
  v_exp_f32 v69, v69
  v_mfma_f32_32x32x16_bf16 v[80:95], v[112:115], v[168:171], 0
  v_exp_f32 v70, v70
  v_cvt_pk_bf16_f32 v14, v68, v69
  v_exp_f32 v71, v71
  v_exp_f32 v72, v72
  v_cvt_pk_bf16_f32 v15, v70, v71
  v_mfma_f32_32x32x16_bf16 v[80:95], v[116:119], v[172:175], v[80:95]
  v_exp_f32 v73, v73
  v_exp_f32 v74, v74
  v_cvt_pk_bf16_f32 v16, v72, v73
  v_exp_f32 v75, v75
  v_exp_f32 v76, v76
  v_cvt_pk_bf16_f32 v17, v74, v75
  s_waitcnt vmcnt(9)
  v_mfma_f32_32x32x16_bf16 v[192:207], v[120:123], v[12:15], v[192:207]
  v_exp_f32 v77, v77
  v_exp_f32 v78, v78
  v_cvt_pk_bf16_f32 v18, v76, v77
  v_exp_f32 v79, v79
  v_exp_f32 v80, v80
  v_cvt_pk_bf16_f32 v19, v78, v79
  v_exp_f32 v81, v81
  v_exp_f32 v82, v82
  s_waitcnt vmcnt(8)
  v_mfma_f32_32x32x16_bf16 v[192:207], v[124:127], v[16:19], v[192:207]
  v_exp_f32 v83, v83
  v_cvt_pk_bf16_f32 v12, v80, v81
  v_exp_f32 v84, v84
  v_cvt_pk_bf16_f32 v13, v82, v83
  v_exp_f32 v85, v85
  v_mfma_f32_32x32x16_bf16 v[64:79], v[112:115], v[176:179], 0
  v_exp_f32 v86, v86
  v_cvt_pk_bf16_f32 v14, v84, v85
  v_exp_f32 v87, v87
  v_exp_f32 v88, v88
  v_cvt_pk_bf16_f32 v15, v86, v87
  v_mfma_f32_32x32x16_bf16 v[64:79], v[116:119], v[180:183], v[64:79]
  v_exp_f32 v89, v89
  v_exp_f32 v90, v90
  v_cvt_pk_bf16_f32 v16, v88, v89
  v_exp_f32 v91, v91
  v_exp_f32 v92, v92
  v_cvt_pk_bf16_f32 v17, v90, v91
  v_mfma_f32_32x32x16_bf16 v[208:223], v[120:123], v[12:15], v[208:223]
  v_exp_f32 v93, v93
  v_exp_f32 v94, v94
  v_cvt_pk_bf16_f32 v18, v92, v93
  v_exp_f32 v95, v95
  s_nop 0
  v_exp_f32 v64, v64
  v_cvt_pk_bf16_f32 v19, v94, v95
  v_exp_f32 v65, v65
  v_exp_f32 v66, v66
  v_mfma_f32_32x32x16_bf16 v[208:223], v[124:127], v[16:19], v[208:223]
  v_exp_f32 v67, v67
  v_cvt_pk_bf16_f32 v12, v64, v65
  v_exp_f32 v68, v68
  v_cvt_pk_bf16_f32 v13, v66, v67
  v_exp_f32 v69, v69
  v_mfma_f32_32x32x16_bf16 v[80:95], v[112:115], v[184:187], 0
  v_exp_f32 v70, v70
  v_cvt_pk_bf16_f32 v14, v68, v69
  v_exp_f32 v71, v71
  v_exp_f32 v72, v72
  v_cvt_pk_bf16_f32 v15, v70, v71
  v_mfma_f32_32x32x16_bf16 v[80:95], v[116:119], v[188:191], v[80:95]
  v_exp_f32 v73, v73
  v_exp_f32 v74, v74
  v_cvt_pk_bf16_f32 v16, v72, v73
  v_exp_f32 v75, v75
  v_exp_f32 v76, v76
  v_cvt_pk_bf16_f32 v17, v74, v75
  v_mfma_f32_32x32x16_bf16 v[224:239], v[120:123], v[12:15], v[224:239]
  v_exp_f32 v77, v77
  v_exp_f32 v78, v78
  v_cvt_pk_bf16_f32 v18, v76, v77
  v_exp_f32 v79, v79
  s_nop 0
  v_exp_f32 v80, v80
  v_cvt_pk_bf16_f32 v19, v78, v79
  v_exp_f32 v81, v81
  v_exp_f32 v82, v82
  v_mfma_f32_32x32x16_bf16 v[224:239], v[124:127], v[16:19], v[224:239]
  v_exp_f32 v83, v83
  v_cvt_pk_bf16_f32 v12, v80, v81
  v_exp_f32 v84, v84
  v_cvt_pk_bf16_f32 v13, v82, v83
  v_exp_f32 v85, v85
  s_waitcnt vmcnt(7)
  v_mfma_f32_32x32x16_bf16 v[64:79], v[128:131], v[160:163], 0
  v_exp_f32 v86, v86
  v_cvt_pk_bf16_f32 v14, v84, v85
  v_exp_f32 v87, v87
  v_exp_f32 v88, v88
  v_cvt_pk_bf16_f32 v15, v86, v87
  s_waitcnt vmcnt(6)
  v_mfma_f32_32x32x16_bf16 v[64:79], v[132:135], v[164:167], v[64:79]
  v_exp_f32 v89, v89
  v_exp_f32 v90, v90
  v_cvt_pk_bf16_f32 v16, v88, v89
  v_exp_f32 v91, v91
  v_exp_f32 v92, v92
  v_cvt_pk_bf16_f32 v17, v90, v91
  v_mfma_f32_32x32x16_bf16 v[240:255], v[120:123], v[12:15], v[240:255]
  v_exp_f32 v93, v93
  v_exp_f32 v94, v94
  v_cvt_pk_bf16_f32 v18, v92, v93
  v_exp_f32 v95, v95
  s_nop 0
  v_exp_f32 v64, v64
  v_cvt_pk_bf16_f32 v19, v94, v95
  v_exp_f32 v65, v65
  v_exp_f32 v66, v66
  s_lshl_b32 s70, s54, 15
  v_mfma_f32_32x32x16_bf16 v[240:255], v[124:127], v[16:19], v[240:255]
  v_exp_f32 v67, v67
  s_lshl_b32 s64, s52, 11
  v_cvt_pk_bf16_f32 v12, v64, v65
  v_exp_f32 v68, v68
  s_add_u32 s70, s70, s64
  v_cvt_pk_bf16_f32 v13, v66, v67
  v_exp_f32 v69, v69
  s_add_u32 s70, s70, 6291456
  s_waitcnt vmcnt(3)
  v_mfma_f32_32x32x16_bf16 v[80:95], v[144:147], v[160:163], 0
  v_exp_f32 v70, v70
  s_lshl_b32 s64, s55, 13
  v_cvt_pk_bf16_f32 v14, v68, v69
  v_exp_f32 v71, v71
  s_add_u32 s67, s70, s64
  v_exp_f32 v72, v72
  s_add_u32 s68, s62, 32768
  v_cvt_pk_bf16_f32 v15, v70, v71
  s_waitcnt vmcnt(2)
  v_mfma_f32_32x32x16_bf16 v[80:95], v[148:151], v[164:167], v[80:95]
  v_exp_f32 v73, v73
  v_exp_f32 v74, v74
  v_cvt_pk_bf16_f32 v16, v72, v73
  v_exp_f32 v75, v75
  v_exp_f32 v76, v76
  v_cvt_pk_bf16_f32 v17, v74, v75
  v_mfma_f32_32x32x16_bf16 v[192:207], v[136:139], v[12:15], v[192:207]
  v_exp_f32 v77, v77
  v_exp_f32 v78, v78
  v_cvt_pk_bf16_f32 v18, v76, v77
  v_exp_f32 v79, v79
  s_nop 0
  v_exp_f32 v80, v80
  v_cvt_pk_bf16_f32 v19, v78, v79
  v_exp_f32 v81, v81
  v_exp_f32 v82, v82
  v_mfma_f32_32x32x16_bf16 v[192:207], v[140:143], v[16:19], v[192:207]
  v_exp_f32 v83, v83
  v_cvt_pk_bf16_f32 v12, v80, v81
  v_exp_f32 v84, v84
  v_cvt_pk_bf16_f32 v13, v82, v83
  v_exp_f32 v85, v85
  v_mfma_f32_32x32x16_bf16 v[64:79], v[128:131], v[168:171], 0
  v_exp_f32 v86, v86
  v_cvt_pk_bf16_f32 v14, v84, v85
  v_exp_f32 v87, v87
  v_exp_f32 v88, v88
  v_cvt_pk_bf16_f32 v15, v86, v87
  v_mfma_f32_32x32x16_bf16 v[64:79], v[132:135], v[172:175], v[64:79]
  v_exp_f32 v89, v89
  v_exp_f32 v90, v90
  v_cvt_pk_bf16_f32 v16, v88, v89
  v_exp_f32 v91, v91
  v_exp_f32 v92, v92
  v_cvt_pk_bf16_f32 v17, v90, v91
  s_waitcnt vmcnt(1)
  v_mfma_f32_32x32x16_bf16 v[192:207], v[152:155], v[12:15], v[192:207]
  v_exp_f32 v93, v93
  v_exp_f32 v94, v94
  v_cvt_pk_bf16_f32 v18, v92, v93
  v_exp_f32 v95, v95
  v_exp_f32 v64, v64
  v_cvt_pk_bf16_f32 v19, v94, v95
  v_exp_f32 v65, v65
  v_exp_f32 v66, v66
  s_waitcnt vmcnt(0)
  v_mfma_f32_32x32x16_bf16 v[192:207], v[156:159], v[16:19], v[192:207]
  v_exp_f32 v67, v67
  v_cvt_pk_bf16_f32 v12, v64, v65
  v_exp_f32 v68, v68
  v_cvt_pk_bf16_f32 v13, v66, v67
  v_exp_f32 v69, v69
  v_mfma_f32_32x32x16_bf16 v[80:95], v[144:147], v[168:171], 0
  v_exp_f32 v70, v70
  v_cvt_pk_bf16_f32 v14, v68, v69
  v_exp_f32 v71, v71
  s_nop 2
  ds_write_b128 v44, v[192:195] offset:0
  v_exp_f32 v72, v72
  v_cvt_pk_bf16_f32 v15, v70, v71
  v_mfma_f32_32x32x16_bf16 v[80:95], v[148:151], v[172:175], v[80:95]
  v_exp_f32 v73, v73
  v_exp_f32 v74, v74
  v_cvt_pk_bf16_f32 v16, v72, v73
  v_exp_f32 v75, v75
  v_exp_f32 v76, v76
  v_cvt_pk_bf16_f32 v17, v74, v75
  v_mfma_f32_32x32x16_bf16 v[208:223], v[136:139], v[12:15], v[208:223]
  v_exp_f32 v77, v77
  ds_write_b128 v44, v[196:199] offset:1024
  v_exp_f32 v78, v78
  v_cvt_pk_bf16_f32 v18, v76, v77
  v_exp_f32 v79, v79
  v_exp_f32 v80, v80
  v_cvt_pk_bf16_f32 v19, v78, v79
  v_exp_f32 v81, v81
  v_exp_f32 v82, v82
  v_mfma_f32_32x32x16_bf16 v[208:223], v[140:143], v[16:19], v[208:223]
  v_exp_f32 v83, v83
  ds_write_b128 v44, v[200:203] offset:2048
  v_cvt_pk_bf16_f32 v12, v80, v81
  v_exp_f32 v84, v84
  v_cvt_pk_bf16_f32 v13, v82, v83
  v_exp_f32 v85, v85
  v_mfma_f32_32x32x16_bf16 v[64:79], v[128:131], v[176:179], 0
  v_exp_f32 v86, v86
  v_cvt_pk_bf16_f32 v14, v84, v85
  v_exp_f32 v87, v87
  v_exp_f32 v88, v88
  v_cvt_pk_bf16_f32 v15, v86, v87
  v_mfma_f32_32x32x16_bf16 v[64:79], v[132:135], v[180:183], v[64:79]
  v_exp_f32 v89, v89
  ds_write_b128 v44, v[204:207] offset:3072
  v_exp_f32 v90, v90
  v_cvt_pk_bf16_f32 v16, v88, v89
  v_exp_f32 v91, v91
  v_exp_f32 v92, v92
  v_cvt_pk_bf16_f32 v17, v90, v91
  v_mfma_f32_32x32x16_bf16 v[208:223], v[152:155], v[12:15], v[208:223]
  v_exp_f32 v93, v93
  v_exp_f32 v94, v94
  v_cvt_pk_bf16_f32 v18, v92, v93
  v_exp_f32 v95, v95
  v_exp_f32 v64, v64
  v_cvt_pk_bf16_f32 v19, v94, v95
  v_exp_f32 v65, v65
  v_exp_f32 v66, v66
  v_mfma_f32_32x32x16_bf16 v[208:223], v[156:159], v[16:19], v[208:223]
  v_exp_f32 v67, v67
  v_cvt_pk_bf16_f32 v12, v64, v65
  v_exp_f32 v68, v68
  v_cvt_pk_bf16_f32 v13, v66, v67
  v_exp_f32 v69, v69
  v_mfma_f32_32x32x16_bf16 v[80:95], v[144:147], v[176:179], 0
  v_exp_f32 v70, v70
  v_cvt_pk_bf16_f32 v14, v68, v69
  v_exp_f32 v71, v71
  s_nop 2
  ds_write_b128 v45, v[208:211] offset:0
  v_exp_f32 v72, v72
  v_cvt_pk_bf16_f32 v15, v70, v71
  v_mfma_f32_32x32x16_bf16 v[80:95], v[148:151], v[180:183], v[80:95]
  v_exp_f32 v73, v73
  v_exp_f32 v74, v74
  v_cvt_pk_bf16_f32 v16, v72, v73
  v_exp_f32 v75, v75
  v_exp_f32 v76, v76
  v_cvt_pk_bf16_f32 v17, v74, v75
  v_mfma_f32_32x32x16_bf16 v[224:239], v[136:139], v[12:15], v[224:239]
  v_exp_f32 v77, v77
  ds_write_b128 v45, v[212:215] offset:1024
  v_exp_f32 v78, v78
  v_cvt_pk_bf16_f32 v18, v76, v77
  v_exp_f32 v79, v79
  v_exp_f32 v80, v80
  v_cvt_pk_bf16_f32 v19, v78, v79
  v_exp_f32 v81, v81
  v_exp_f32 v82, v82
  v_mfma_f32_32x32x16_bf16 v[224:239], v[140:143], v[16:19], v[224:239]
  v_exp_f32 v83, v83
  ds_write_b128 v45, v[216:219] offset:2048
  v_cvt_pk_bf16_f32 v12, v80, v81
  v_exp_f32 v84, v84
  v_cvt_pk_bf16_f32 v13, v82, v83
  v_exp_f32 v85, v85
  v_mfma_f32_32x32x16_bf16 v[64:79], v[128:131], v[184:187], 0
  v_exp_f32 v86, v86
  v_cvt_pk_bf16_f32 v14, v84, v85
  v_exp_f32 v87, v87
  v_exp_f32 v88, v88
  v_cvt_pk_bf16_f32 v15, v86, v87
  v_mfma_f32_32x32x16_bf16 v[64:79], v[132:135], v[188:191], v[64:79]
  v_exp_f32 v89, v89
  ds_write_b128 v45, v[220:223] offset:3072
  v_exp_f32 v90, v90
  v_cvt_pk_bf16_f32 v16, v88, v89
  v_exp_f32 v91, v91
  v_exp_f32 v92, v92
  v_cvt_pk_bf16_f32 v17, v90, v91
  v_mfma_f32_32x32x16_bf16 v[224:239], v[152:155], v[12:15], v[224:239]
  v_exp_f32 v93, v93
  v_exp_f32 v94, v94
  v_cvt_pk_bf16_f32 v18, v92, v93
  v_exp_f32 v95, v95
  v_exp_f32 v64, v64
  v_cvt_pk_bf16_f32 v19, v94, v95
  v_exp_f32 v65, v65
  v_exp_f32 v66, v66
  v_mfma_f32_32x32x16_bf16 v[224:239], v[156:159], v[16:19], v[224:239]
  v_exp_f32 v67, v67
  v_cvt_pk_bf16_f32 v12, v64, v65
  v_exp_f32 v68, v68
  v_cvt_pk_bf16_f32 v13, v66, v67
  v_exp_f32 v69, v69
  v_mfma_f32_32x32x16_bf16 v[80:95], v[144:147], v[184:187], 0
  v_exp_f32 v70, v70
  s_nop 4
  ds_write_b128 v46, v[224:227] offset:0
  v_cvt_pk_bf16_f32 v14, v68, v69
  v_exp_f32 v71, v71
  v_exp_f32 v72, v72
  v_cvt_pk_bf16_f32 v15, v70, v71
  v_mfma_f32_32x32x16_bf16 v[80:95], v[148:151], v[188:191], v[80:95]
  v_exp_f32 v73, v73
  ds_write_b128 v46, v[228:231] offset:1024
  v_exp_f32 v74, v74
  v_cvt_pk_bf16_f32 v16, v72, v73
  v_exp_f32 v75, v75
  v_exp_f32 v76, v76
  ds_write_b128 v46, v[232:235] offset:2048
  v_cvt_pk_bf16_f32 v17, v74, v75
  v_mfma_f32_32x32x16_bf16 v[240:255], v[136:139], v[12:15], v[240:255]
  v_exp_f32 v77, v77
  v_exp_f32 v78, v78
  v_cvt_pk_bf16_f32 v18, v76, v77
  v_exp_f32 v79, v79
  ds_write_b128 v46, v[236:239] offset:3072
  v_exp_f32 v80, v80
  v_cvt_pk_bf16_f32 v19, v78, v79
  v_exp_f32 v81, v81
  v_exp_f32 v82, v82
  v_mfma_f32_32x32x16_bf16 v[240:255], v[140:143], v[16:19], v[240:255]
  v_exp_f32 v83, v83
  s_waitcnt lgkmcnt(0)
  s_barrier
  ds_read_b128 v[204:207], v47 offset:3072
  v_cvt_pk_bf16_f32 v12, v80, v81
  v_exp_f32 v84, v84
  ds_read_b128 v[220:223], v47 offset:7168
  v_cvt_pk_bf16_f32 v13, v82, v83
  v_exp_f32 v85, v85
  ds_read_b128 v[236:239], v47 offset:11264
  v_exp_f32 v86, v86
  ds_read_b128 v[192:195], v47 offset:0
  v_cvt_pk_bf16_f32 v14, v84, v85
  v_exp_f32 v87, v87
  ds_read_b128 v[208:211], v47 offset:4096
  v_exp_f32 v88, v88
  ds_read_b128 v[224:227], v47 offset:8192
  v_cvt_pk_bf16_f32 v15, v86, v87
  v_exp_f32 v89, v89
  ds_read_b128 v[196:199], v47 offset:1024
  v_exp_f32 v90, v90
  ds_read_b128 v[212:215], v47 offset:5120
  v_cvt_pk_bf16_f32 v16, v88, v89
  v_exp_f32 v91, v91
  ds_read_b128 v[228:231], v47 offset:9216
  v_exp_f32 v92, v92
  ds_read_b128 v[200:203], v47 offset:2048
  v_cvt_pk_bf16_f32 v17, v90, v91
  v_mfma_f32_32x32x16_bf16 v[240:255], v[152:155], v[12:15], v[240:255]
  v_exp_f32 v93, v93
  ds_read_b128 v[216:219], v47 offset:6144
  v_exp_f32 v94, v94
  ds_read_b128 v[232:235], v47 offset:10240
  v_cvt_pk_bf16_f32 v18, v92, v93
  v_exp_f32 v95, v95
  s_nop 0
  v_cvt_pk_bf16_f32 v19, v94, v95
  s_nop 1
  v_mfma_f32_32x32x16_bf16 v[240:255], v[156:159], v[16:19], v[240:255]
  s_waitcnt lgkmcnt(10)
  v_pk_add_f32 v[204:205], v[204:205], v[220:221]
  v_pk_add_f32 v[206:207], v[206:207], v[222:223]
  s_waitcnt lgkmcnt(9)
  v_pk_add_f32 v[204:205], v[204:205], v[236:237]
  v_pk_add_f32 v[206:207], v[206:207], v[238:239]
  s_waitcnt lgkmcnt(7)
  v_pk_add_f32 v[192:193], v[192:193], v[208:209]
  v_pk_add_f32 v[194:195], v[194:195], v[210:211]
  s_waitcnt lgkmcnt(6)
  v_pk_add_f32 v[192:193], v[192:193], v[224:225]
  v_pk_add_f32 v[194:195], v[194:195], v[226:227]
  s_waitcnt lgkmcnt(4)
  v_pk_add_f32 v[196:197], v[196:197], v[212:213]
  v_pk_add_f32 v[198:199], v[198:199], v[214:215]
  s_waitcnt lgkmcnt(3)
  v_pk_add_f32 v[196:197], v[196:197], v[228:229]
  v_pk_add_f32 v[198:199], v[198:199], v[230:231]
  s_waitcnt lgkmcnt(1)
  v_pk_add_f32 v[200:201], v[200:201], v[216:217]
  v_pk_add_f32 v[202:203], v[202:203], v[218:219]
  s_waitcnt lgkmcnt(0)
  v_pk_add_f32 v[200:201], v[200:201], v[232:233]
  v_pk_add_f32 v[202:203], v[202:203], v[234:235]
  v_pk_add_f32 v[252:253], v[252:253], v[204:205]
  v_pk_add_f32 v[254:255], v[254:255], v[206:207]
  v_mov_b32 v6, v252
  v_mov_b32 v7, v252
  v_pk_add_f32 v[240:241], v[240:241], v[192:193]
  v_pk_add_f32 v[242:243], v[242:243], v[194:195]
  v_permlane32_swap_b32 v6, v7
  v_pk_add_f32 v[244:245], v[244:245], v[196:197]
  v_pk_add_f32 v[246:247], v[246:247], v[198:199]
  v_subrev_u32 v6, 562036736, v7
  v_cmp_le_u32 vcc, 1006632960, v6
  v_pk_add_f32 v[248:249], v[248:249], v[200:201]
  v_pk_add_f32 v[250:251], v[250:251], v[202:203]
  s_cbranch_vccnz Lslow_8
Lnorm_9:
  v_rcp_f32 v10, v7
  s_nop 0
  v_pk_mul_f32 v[240:241], v[240:241], v[10:11] op_sel_hi:[1,0]
  v_pk_mul_f32 v[242:243], v[242:243], v[10:11] op_sel_hi:[1,0]
  v_pk_mul_f32 v[244:245], v[244:245], v[10:11] op_sel_hi:[1,0]
  v_pk_mul_f32 v[246:247], v[246:247], v[10:11] op_sel_hi:[1,0]
  v_pk_mul_f32 v[248:249], v[248:249], v[10:11] op_sel_hi:[1,0]
  v_pk_mul_f32 v[250:251], v[250:251], v[10:11] op_sel_hi:[1,0]
  v_pk_mul_f32 v[252:253], v[252:253], v[10:11] op_sel_hi:[1,0]
  v_pk_mul_f32 v[254:255], v[254:255], v[10:11] op_sel_hi:[1,0]
  v_cvt_pk_bf16_f32 v12, v240, v241
  v_cvt_pk_bf16_f32 v13, v242, v243
  v_cvt_pk_bf16_f32 v14, v244, v245
  v_cvt_pk_bf16_f32 v15, v246, v247
  v_cvt_pk_bf16_f32 v16, v248, v249
  v_cvt_pk_bf16_f32 v17, v250, v251
  v_cvt_pk_bf16_f32 v18, v252, v253
  v_cvt_pk_bf16_f32 v19, v254, v255
  s_cmp_eq_u32 s61, 0
  s_cbranch_scc1 Lnl_10
  buffer_store_dwordx4 v[12:15], v2, s[24:27], s67 offen
  buffer_store_dwordx4 v[16:19], v2, s[24:27], s67 offen offset:1024
Lnle_11:
  ds_write_b128 v47, v[12:15]
  ds_write_b128 v47, v[16:19] offset:1024
  s_lshl_b32 s63, s54, 6
  s_lshl_b32 s64, s52, 2
  s_add_u32 s63, s63, s64
  s_add_u32 s63, s63, 32768
  v_and_b32 v8, 3, v1
  v_lshlrev_b32 v8, 4, v8
  s_mul_i32 s65, s52, 12288
  s_add_u32 s65, s65, 114688
  s_waitcnt vmcnt(0)
  s_mov_b64 exec, 1
  s_cmp_eq_u32 s61, 0
  s_cbranch_scc1 Lnl_12
  buffer_store_dword v3, off, s[24:27], s68
Lnle_13:
  s_mov_b64 exec, -1
  s_waitcnt lgkmcnt(0)
  s_barrier
  s_add_u32 s66, s55, 1
  s_and_b32 s66, s66, 3
  s_add_u32 s80, s65, 2048
  s_lshl_b32 s66, s66, 13
  s_add_u32 s81, s66, s70
  s_add_u32 s66, s55, 2
  s_and_b32 s66, s66, 3
  s_add_u32 s82, s65, 4096
  s_lshl_b32 s66, s66, 13
  s_add_u32 s83, s66, s70
  s_add_u32 s66, s55, 3
  s_and_b32 s66, s66, 3
  s_add_u32 s84, s65, 6144
  s_lshl_b32 s66, s66, 13
  s_add_u32 s85, s66, s70
Lpoll_14:
  buffer_load_dword v7, v8, s[24:27], s63 offen sc1
  s_sub_u32 s59, s59, 1
  s_cmp_lt_i32 s59, 0
  s_cbranch_scc1 Lpdone_15
  s_waitcnt vmcnt(0)
  v_cmp_ne_u32 vcc, v3, v7
  s_cbranch_vccnz Lpoll_14
Lpdone_15:
  s_mov_b32 m0, s80
  s_nop 0
  buffer_load_dwordx4 v2, s[24:27], s81 offen sc1 lds
  buffer_load_dwordx4 v2, s[24:27], s81 offen offset:1024 sc1 lds
  s_mov_b32 m0, s82
  s_nop 0
  buffer_load_dwordx4 v2, s[24:27], s83 offen sc1 lds
  buffer_load_dwordx4 v2, s[24:27], s83 offen offset:1024 sc1 lds
  s_mov_b32 m0, s84
  s_nop 0
  buffer_load_dwordx4 v2, s[24:27], s85 offen sc1 lds
  buffer_load_dwordx4 v2, s[24:27], s85 offen offset:1024 sc1 lds
  s_setprio 0
  s_lshl_b32 s63, s69, 6
  s_add_u32 s63, s63, 36864
  v_lshlrev_b32 v8, 2, v4
  s_lshl_b32 s70, s69, 15
  s_add_u32 s70, s70, 6291456
  s_add_u32 s71, s62, 40960
  v_mov_b32 v10, v2
  v_add_u32 v11, 57344, v2
  v_add_u32 v12, 114688, v2
  v_lshlrev_b32 v13, 4, v4
  v_lshl_add_u32 v13, v5, 9, v13
  s_waitcnt vmcnt(0)
  s_waitcnt lgkmcnt(0)
  s_barrier
  s_barrier
  ds_read_b128 v[128:131], v10 offset:0
  ds_read_b128 v[132:135], v10 offset:1024
  ds_read_b128 v[136:139], v10 offset:28672
  ds_read_b128 v[140:143], v10 offset:29696
  ds_read_b128 v[144:147], v11 offset:0
  ds_read_b128 v[148:151], v11 offset:1024
  ds_read_b128 v[152:155], v10 offset:2048
  s_barrier
Lpoll_16:
  buffer_load_dword v7, v8, s[24:27], s63 offen sc1
  s_sub_u32 s59, s59, 1
  s_cmp_lt_i32 s59, 0
  s_cbranch_scc1 Lpdone_17
  s_waitcnt vmcnt(0)
  v_cmp_ne_u32 vcc, v3, v7
  s_cbranch_vccnz Lpoll_16
Lpdone_17:
  s_setprio 2
  buffer_load_dwordx4 v[16:19], v13, s[24:27], s70 offen offset:0 sc1
  buffer_load_dwordx4 v[20:23], v13, s[24:27], s70 offen offset:256 sc1
  buffer_load_dwordx4 v[24:27], v13, s[24:27], s70 offen offset:2048 sc1
  buffer_load_dwordx4 v[28:31], v13, s[24:27], s70 offen offset:2304 sc1
  s_add_u32 s70, s70, 4096
  buffer_load_dwordx4 v[32:35], v13, s[24:27], s70 offen offset:0 sc1
  buffer_load_dwordx4 v[36:39], v13, s[24:27], s70 offen offset:256 sc1
  buffer_load_dwordx4 v[40:43], v13, s[24:27], s70 offen offset:2048 sc1
  buffer_load_dwordx4 v[44:47], v13, s[24:27], s70 offen offset:2304 sc1
  s_add_u32 s70, s70, 4096
  buffer_load_dwordx4 v[48:51], v13, s[24:27], s70 offen offset:0 sc1
  buffer_load_dwordx4 v[52:55], v13, s[24:27], s70 offen offset:256 sc1
  s_waitcnt vmcnt(9) lgkmcnt(6)
  v_mfma_f32_16x16x32_bf16 v[160:163], v[128:131], v[16:19], 0
  buffer_load_dwordx4 v[56:59], v13, s[24:27], s70 offen offset:2048 sc1
  s_waitcnt vmcnt(9)
  v_mfma_f32_16x16x32_bf16 v[164:167], v[128:131], v[20:23], 0
  buffer_load_dwordx4 v[60:63], v13, s[24:27], s70 offen offset:2304 sc1
  ds_read_b128 v[156:159], v10 offset:3072
  s_waitcnt lgkmcnt(6)
  v_mfma_f32_16x16x32_bf16 v[168:171], v[132:135], v[16:19], 0
  v_mfma_f32_16x16x32_bf16 v[172:175], v[132:135], v[20:23], 0
  ds_read_b128 v[128:131], v10 offset:30720
  s_waitcnt lgkmcnt(6)
  v_mfma_f32_16x16x32_bf16 v[176:179], v[136:139], v[16:19], 0
  v_mfma_f32_16x16x32_bf16 v[180:183], v[136:139], v[20:23], 0
  ds_read_b128 v[132:135], v10 offset:31744
  s_waitcnt lgkmcnt(6)
  v_mfma_f32_16x16x32_bf16 v[184:187], v[140:143], v[16:19], 0
  v_mfma_f32_16x16x32_bf16 v[188:191], v[140:143], v[20:23], 0
  ds_read_b128 v[136:139], v11 offset:2048
  s_waitcnt lgkmcnt(6)
  v_mfma_f32_16x16x32_bf16 v[192:195], v[144:147], v[16:19], 0
  s_add_u32 s70, s70, 4096
  buffer_load_dwordx4 v[64:67], v13, s[24:27], s70 offen offset:0 sc1
  v_mfma_f32_16x16x32_bf16 v[196:199], v[144:147], v[20:23], 0
  buffer_load_dwordx4 v[68:71], v13, s[24:27], s70 offen offset:256 sc1
  ds_read_b128 v[140:143], v11 offset:3072
  s_waitcnt lgkmcnt(6)
  v_mfma_f32_16x16x32_bf16 v[200:203], v[148:151], v[16:19], 0
  v_mfma_f32_16x16x32_bf16 v[204:207], v[148:151], v[20:23], 0
  ds_read_b128 v[144:147], v10 offset:4096
  s_waitcnt vmcnt(11) lgkmcnt(6)
  v_mfma_f32_16x16x32_bf16 v[160:163], v[152:155], v[24:27], v[160:163]
  s_waitcnt vmcnt(10)
  v_mfma_f32_16x16x32_bf16 v[164:167], v[152:155], v[28:31], v[164:167]
  ds_read_b128 v[148:151], v10 offset:5120
  s_waitcnt lgkmcnt(6)
  v_mfma_f32_16x16x32_bf16 v[168:171], v[156:159], v[24:27], v[168:171]
  v_mfma_f32_16x16x32_bf16 v[172:175], v[156:159], v[28:31], v[172:175]
  ds_read_b128 v[152:155], v10 offset:32768
  s_waitcnt lgkmcnt(6)
  v_mfma_f32_16x16x32_bf16 v[176:179], v[128:131], v[24:27], v[176:179]
  buffer_load_dwordx4 v[72:75], v13, s[24:27], s70 offen offset:2048 sc1
  v_mfma_f32_16x16x32_bf16 v[180:183], v[128:131], v[28:31], v[180:183]
  buffer_load_dwordx4 v[76:79], v13, s[24:27], s70 offen offset:2304 sc1
  ds_read_b128 v[156:159], v10 offset:33792
  s_waitcnt lgkmcnt(6)
  v_mfma_f32_16x16x32_bf16 v[184:187], v[132:135], v[24:27], v[184:187]
  v_mfma_f32_16x16x32_bf16 v[188:191], v[132:135], v[28:31], v[188:191]
  ds_read_b128 v[128:131], v11 offset:4096
  s_waitcnt lgkmcnt(6)
  v_mfma_f32_16x16x32_bf16 v[192:195], v[136:139], v[24:27], v[192:195]
  v_mfma_f32_16x16x32_bf16 v[196:199], v[136:139], v[28:31], v[196:199]
  ds_read_b128 v[132:135], v11 offset:5120
  s_waitcnt lgkmcnt(6)
  v_mfma_f32_16x16x32_bf16 v[200:203], v[140:143], v[24:27], v[200:203]
  v_mfma_f32_16x16x32_bf16 v[204:207], v[140:143], v[28:31], v[204:207]
  ds_read_b128 v[136:139], v10 offset:6144
  s_waitcnt vmcnt(11) lgkmcnt(6)
  v_mfma_f32_16x16x32_bf16 v[160:163], v[144:147], v[32:35], v[160:163]
  s_add_u32 s70, s70, 4096
  buffer_load_dwordx4 v[80:83], v13, s[24:27], s70 offen offset:0 sc1
  s_waitcnt vmcnt(11)
  v_mfma_f32_16x16x32_bf16 v[164:167], v[144:147], v[36:39], v[164:167]
  buffer_load_dwordx4 v[84:87], v13, s[24:27], s70 offen offset:256 sc1
  ds_read_b128 v[140:143], v10 offset:7168
  s_waitcnt lgkmcnt(6)
  v_mfma_f32_16x16x32_bf16 v[168:171], v[148:151], v[32:35], v[168:171]
  v_mfma_f32_16x16x32_bf16 v[172:175], v[148:151], v[36:39], v[172:175]
  ds_read_b128 v[144:147], v10 offset:34816
  s_waitcnt lgkmcnt(6)
  v_mfma_f32_16x16x32_bf16 v[176:179], v[152:155], v[32:35], v[176:179]
  v_mfma_f32_16x16x32_bf16 v[180:183], v[152:155], v[36:39], v[180:183]
  ds_read_b128 v[148:151], v10 offset:35840
  s_waitcnt lgkmcnt(6)
  v_mfma_f32_16x16x32_bf16 v[184:187], v[156:159], v[32:35], v[184:187]
  v_mfma_f32_16x16x32_bf16 v[188:191], v[156:159], v[36:39], v[188:191]
  ds_read_b128 v[152:155], v11 offset:6144
  s_waitcnt lgkmcnt(6)
  v_mfma_f32_16x16x32_bf16 v[192:195], v[128:131], v[32:35], v[192:195]
  buffer_load_dwordx4 v[88:91], v13, s[24:27], s70 offen offset:2048 sc1
  v_mfma_f32_16x16x32_bf16 v[196:199], v[128:131], v[36:39], v[196:199]
  buffer_load_dwordx4 v[92:95], v13, s[24:27], s70 offen offset:2304 sc1
  ds_read_b128 v[156:159], v11 offset:7168
  s_waitcnt lgkmcnt(6)
  v_mfma_f32_16x16x32_bf16 v[200:203], v[132:135], v[32:35], v[200:203]
  v_mfma_f32_16x16x32_bf16 v[204:207], v[132:135], v[36:39], v[204:207]
  ds_read_b128 v[128:131], v10 offset:8192
  s_waitcnt vmcnt(13) lgkmcnt(6)
  v_mfma_f32_16x16x32_bf16 v[160:163], v[136:139], v[40:43], v[160:163]
  s_waitcnt vmcnt(12)
  v_mfma_f32_16x16x32_bf16 v[164:167], v[136:139], v[44:47], v[164:167]
  ds_read_b128 v[132:135], v10 offset:9216
  s_waitcnt lgkmcnt(6)
  v_mfma_f32_16x16x32_bf16 v[168:171], v[140:143], v[40:43], v[168:171]
  v_mfma_f32_16x16x32_bf16 v[172:175], v[140:143], v[44:47], v[172:175]
  ds_read_b128 v[136:139], v10 offset:36864
  s_waitcnt lgkmcnt(6)
  v_mfma_f32_16x16x32_bf16 v[176:179], v[144:147], v[40:43], v[176:179]
  s_add_u32 s70, s70, 4096
  buffer_load_dwordx4 v[96:99], v13, s[24:27], s70 offen offset:0 sc1
  v_mfma_f32_16x16x32_bf16 v[180:183], v[144:147], v[44:47], v[180:183]
  buffer_load_dwordx4 v[100:103], v13, s[24:27], s70 offen offset:256 sc1
  ds_read_b128 v[140:143], v10 offset:37888
  s_waitcnt lgkmcnt(6)
  v_mfma_f32_16x16x32_bf16 v[184:187], v[148:151], v[40:43], v[184:187]
  v_mfma_f32_16x16x32_bf16 v[188:191], v[148:151], v[44:47], v[188:191]
  ds_read_b128 v[144:147], v11 offset:8192
  s_waitcnt lgkmcnt(6)
  v_mfma_f32_16x16x32_bf16 v[192:195], v[152:155], v[40:43], v[192:195]
  v_mfma_f32_16x16x32_bf16 v[196:199], v[152:155], v[44:47], v[196:199]
  ds_read_b128 v[148:151], v11 offset:9216
  s_waitcnt lgkmcnt(6)
  v_mfma_f32_16x16x32_bf16 v[200:203], v[156:159], v[40:43], v[200:203]
  v_mfma_f32_16x16x32_bf16 v[204:207], v[156:159], v[44:47], v[204:207]
  ds_read_b128 v[152:155], v10 offset:10240
  s_waitcnt vmcnt(13) lgkmcnt(6)
  v_mfma_f32_16x16x32_bf16 v[160:163], v[128:131], v[48:51], v[160:163]
  buffer_load_dwordx4 v[104:107], v13, s[24:27], s70 offen offset:2048 sc1
  s_waitcnt vmcnt(13)
  v_mfma_f32_16x16x32_bf16 v[164:167], v[128:131], v[52:55], v[164:167]
  buffer_load_dwordx4 v[108:111], v13, s[24:27], s70 offen offset:2304 sc1
  ds_read_b128 v[156:159], v10 offset:11264
  s_waitcnt lgkmcnt(6)
  v_mfma_f32_16x16x32_bf16 v[168:171], v[132:135], v[48:51], v[168:171]
  v_mfma_f32_16x16x32_bf16 v[172:175], v[132:135], v[52:55], v[172:175]
  ds_read_b128 v[128:131], v10 offset:38912
  s_waitcnt lgkmcnt(6)
  v_mfma_f32_16x16x32_bf16 v[176:179], v[136:139], v[48:51], v[176:179]
  v_mfma_f32_16x16x32_bf16 v[180:183], v[136:139], v[52:55], v[180:183]
  ds_read_b128 v[132:135], v10 offset:39936
  s_waitcnt lgkmcnt(6)
  v_mfma_f32_16x16x32_bf16 v[184:187], v[140:143], v[48:51], v[184:187]
  v_mfma_f32_16x16x32_bf16 v[188:191], v[140:143], v[52:55], v[188:191]
  ds_read_b128 v[136:139], v11 offset:10240
  s_waitcnt lgkmcnt(6)
  v_mfma_f32_16x16x32_bf16 v[192:195], v[144:147], v[48:51], v[192:195]
  s_add_u32 s70, s70, 4096
  buffer_load_dwordx4 v[112:115], v13, s[24:27], s70 offen offset:0 sc1
  v_mfma_f32_16x16x32_bf16 v[196:199], v[144:147], v[52:55], v[196:199]
  buffer_load_dwordx4 v[116:119], v13, s[24:27], s70 offen offset:256 sc1
  ds_read_b128 v[140:143], v11 offset:11264
  s_waitcnt lgkmcnt(6)
  v_mfma_f32_16x16x32_bf16 v[200:203], v[148:151], v[48:51], v[200:203]
  v_mfma_f32_16x16x32_bf16 v[204:207], v[148:151], v[52:55], v[204:207]
  ds_read_b128 v[144:147], v10 offset:12288
  s_waitcnt vmcnt(15) lgkmcnt(6)
  v_mfma_f32_16x16x32_bf16 v[160:163], v[152:155], v[56:59], v[160:163]
  s_waitcnt vmcnt(14)
  v_mfma_f32_16x16x32_bf16 v[164:167], v[152:155], v[60:63], v[164:167]
  ds_read_b128 v[148:151], v10 offset:13312
  s_waitcnt lgkmcnt(6)
  v_mfma_f32_16x16x32_bf16 v[168:171], v[156:159], v[56:59], v[168:171]
  v_mfma_f32_16x16x32_bf16 v[172:175], v[156:159], v[60:63], v[172:175]
  ds_read_b128 v[152:155], v10 offset:40960
  s_waitcnt lgkmcnt(6)
  v_mfma_f32_16x16x32_bf16 v[176:179], v[128:131], v[56:59], v[176:179]
  buffer_load_dwordx4 v[120:123], v13, s[24:27], s70 offen offset:2048 sc1
  v_mfma_f32_16x16x32_bf16 v[180:183], v[128:131], v[60:63], v[180:183]
  buffer_load_dwordx4 v[124:127], v13, s[24:27], s70 offen offset:2304 sc1
  s_barrier
  ds_read_b128 v[156:159], v10 offset:41984
  s_waitcnt lgkmcnt(6)
  v_mfma_f32_16x16x32_bf16 v[184:187], v[132:135], v[56:59], v[184:187]
  v_mfma_f32_16x16x32_bf16 v[188:191], v[132:135], v[60:63], v[188:191]
  ds_read_b128 v[128:131], v11 offset:12288
  s_waitcnt lgkmcnt(6)
  v_mfma_f32_16x16x32_bf16 v[192:195], v[136:139], v[56:59], v[192:195]
  v_mfma_f32_16x16x32_bf16 v[196:199], v[136:139], v[60:63], v[196:199]
  ds_read_b128 v[132:135], v11 offset:13312
  s_waitcnt lgkmcnt(6)
  v_mfma_f32_16x16x32_bf16 v[200:203], v[140:143], v[56:59], v[200:203]
  v_mfma_f32_16x16x32_bf16 v[204:207], v[140:143], v[60:63], v[204:207]
  ds_read_b128 v[136:139], v10 offset:14336
  s_waitcnt vmcnt(15) lgkmcnt(6)
  v_mfma_f32_16x16x32_bf16 v[160:163], v[144:147], v[64:67], v[160:163]
  s_waitcnt vmcnt(14)
  v_mfma_f32_16x16x32_bf16 v[164:167], v[144:147], v[68:71], v[164:167]
  ds_read_b128 v[140:143], v10 offset:15360
  s_waitcnt lgkmcnt(6)
  v_mfma_f32_16x16x32_bf16 v[168:171], v[148:151], v[64:67], v[168:171]
  v_mfma_f32_16x16x32_bf16 v[172:175], v[148:151], v[68:71], v[172:175]
  ds_read_b128 v[144:147], v10 offset:43008
  s_waitcnt lgkmcnt(6)
  v_mfma_f32_16x16x32_bf16 v[176:179], v[152:155], v[64:67], v[176:179]
  v_mfma_f32_16x16x32_bf16 v[180:183], v[152:155], v[68:71], v[180:183]
  ds_read_b128 v[148:151], v10 offset:44032
  s_waitcnt lgkmcnt(6)
  v_mfma_f32_16x16x32_bf16 v[184:187], v[156:159], v[64:67], v[184:187]
  v_mfma_f32_16x16x32_bf16 v[188:191], v[156:159], v[68:71], v[188:191]
  ds_read_b128 v[152:155], v11 offset:14336
  s_waitcnt lgkmcnt(6)
  v_mfma_f32_16x16x32_bf16 v[192:195], v[128:131], v[64:67], v[192:195]
  v_mfma_f32_16x16x32_bf16 v[196:199], v[128:131], v[68:71], v[196:199]
  ds_read_b128 v[156:159], v11 offset:15360
  s_waitcnt lgkmcnt(6)
  v_mfma_f32_16x16x32_bf16 v[200:203], v[132:135], v[64:67], v[200:203]
  v_mfma_f32_16x16x32_bf16 v[204:207], v[132:135], v[68:71], v[204:207]
  ds_read_b128 v[128:131], v10 offset:16384
  s_waitcnt vmcnt(13) lgkmcnt(6)
  v_mfma_f32_16x16x32_bf16 v[160:163], v[136:139], v[72:75], v[160:163]
  s_waitcnt vmcnt(12)
  v_mfma_f32_16x16x32_bf16 v[164:167], v[136:139], v[76:79], v[164:167]
  ds_read_b128 v[132:135], v10 offset:17408
  s_waitcnt lgkmcnt(6)
  v_mfma_f32_16x16x32_bf16 v[168:171], v[140:143], v[72:75], v[168:171]
  v_mfma_f32_16x16x32_bf16 v[172:175], v[140:143], v[76:79], v[172:175]
  ds_read_b128 v[136:139], v10 offset:45056
  s_waitcnt lgkmcnt(6)
  v_mfma_f32_16x16x32_bf16 v[176:179], v[144:147], v[72:75], v[176:179]
  v_mfma_f32_16x16x32_bf16 v[180:183], v[144:147], v[76:79], v[180:183]
  ds_read_b128 v[140:143], v10 offset:46080
  s_waitcnt lgkmcnt(6)
  v_mfma_f32_16x16x32_bf16 v[184:187], v[148:151], v[72:75], v[184:187]
  v_mfma_f32_16x16x32_bf16 v[188:191], v[148:151], v[76:79], v[188:191]
  ds_read_b128 v[144:147], v11 offset:16384
  s_waitcnt lgkmcnt(6)
  v_mfma_f32_16x16x32_bf16 v[192:195], v[152:155], v[72:75], v[192:195]
  v_mfma_f32_16x16x32_bf16 v[196:199], v[152:155], v[76:79], v[196:199]
  ds_read_b128 v[148:151], v11 offset:17408
  s_waitcnt lgkmcnt(6)
  v_mfma_f32_16x16x32_bf16 v[200:203], v[156:159], v[72:75], v[200:203]
  v_mfma_f32_16x16x32_bf16 v[204:207], v[156:159], v[76:79], v[204:207]
  ds_read_b128 v[152:155], v10 offset:18432
  s_waitcnt vmcnt(11) lgkmcnt(6)
  v_mfma_f32_16x16x32_bf16 v[160:163], v[128:131], v[80:83], v[160:163]
  s_waitcnt vmcnt(10)
  v_mfma_f32_16x16x32_bf16 v[164:167], v[128:131], v[84:87], v[164:167]
  ds_read_b128 v[156:159], v10 offset:19456
  s_waitcnt lgkmcnt(6)
  v_mfma_f32_16x16x32_bf16 v[168:171], v[132:135], v[80:83], v[168:171]
  v_mfma_f32_16x16x32_bf16 v[172:175], v[132:135], v[84:87], v[172:175]
  ds_read_b128 v[128:131], v10 offset:47104
  s_waitcnt lgkmcnt(6)
  v_mfma_f32_16x16x32_bf16 v[176:179], v[136:139], v[80:83], v[176:179]
  v_mfma_f32_16x16x32_bf16 v[180:183], v[136:139], v[84:87], v[180:183]
  ds_read_b128 v[132:135], v10 offset:48128
  s_waitcnt lgkmcnt(6)
  v_mfma_f32_16x16x32_bf16 v[184:187], v[140:143], v[80:83], v[184:187]
  v_mfma_f32_16x16x32_bf16 v[188:191], v[140:143], v[84:87], v[188:191]
  ds_read_b128 v[136:139], v11 offset:18432
  s_waitcnt lgkmcnt(6)
  v_mfma_f32_16x16x32_bf16 v[192:195], v[144:147], v[80:83], v[192:195]
  v_mfma_f32_16x16x32_bf16 v[196:199], v[144:147], v[84:87], v[196:199]
  ds_read_b128 v[140:143], v11 offset:19456
  s_waitcnt lgkmcnt(6)
  v_mfma_f32_16x16x32_bf16 v[200:203], v[148:151], v[80:83], v[200:203]
  v_mfma_f32_16x16x32_bf16 v[204:207], v[148:151], v[84:87], v[204:207]
  ds_read_b128 v[144:147], v10 offset:20480
  s_waitcnt vmcnt(9) lgkmcnt(6)
  v_mfma_f32_16x16x32_bf16 v[160:163], v[152:155], v[88:91], v[160:163]
  s_waitcnt vmcnt(8)
  v_mfma_f32_16x16x32_bf16 v[164:167], v[152:155], v[92:95], v[164:167]
  ds_read_b128 v[148:151], v10 offset:21504
  s_waitcnt lgkmcnt(6)
  v_mfma_f32_16x16x32_bf16 v[168:171], v[156:159], v[88:91], v[168:171]
  v_mfma_f32_16x16x32_bf16 v[172:175], v[156:159], v[92:95], v[172:175]
  ds_read_b128 v[152:155], v10 offset:49152
  s_waitcnt lgkmcnt(6)
  v_mfma_f32_16x16x32_bf16 v[176:179], v[128:131], v[88:91], v[176:179]
  v_mfma_f32_16x16x32_bf16 v[180:183], v[128:131], v[92:95], v[180:183]
  ds_read_b128 v[156:159], v10 offset:50176
  s_waitcnt lgkmcnt(6)
  v_mfma_f32_16x16x32_bf16 v[184:187], v[132:135], v[88:91], v[184:187]
  v_mfma_f32_16x16x32_bf16 v[188:191], v[132:135], v[92:95], v[188:191]
  ds_read_b128 v[128:131], v11 offset:20480
  s_waitcnt lgkmcnt(6)
  v_mfma_f32_16x16x32_bf16 v[192:195], v[136:139], v[88:91], v[192:195]
  v_mfma_f32_16x16x32_bf16 v[196:199], v[136:139], v[92:95], v[196:199]
  ds_read_b128 v[132:135], v11 offset:21504
  s_waitcnt lgkmcnt(6)
  v_mfma_f32_16x16x32_bf16 v[200:203], v[140:143], v[88:91], v[200:203]
  v_mfma_f32_16x16x32_bf16 v[204:207], v[140:143], v[92:95], v[204:207]
  ds_read_b128 v[136:139], v10 offset:22528
  s_waitcnt vmcnt(7) lgkmcnt(6)
  v_mfma_f32_16x16x32_bf16 v[160:163], v[144:147], v[96:99], v[160:163]
  s_waitcnt vmcnt(6)
  v_mfma_f32_16x16x32_bf16 v[164:167], v[144:147], v[100:103], v[164:167]
  ds_read_b128 v[140:143], v10 offset:23552
  s_waitcnt lgkmcnt(6)
  v_mfma_f32_16x16x32_bf16 v[168:171], v[148:151], v[96:99], v[168:171]
  v_mfma_f32_16x16x32_bf16 v[172:175], v[148:151], v[100:103], v[172:175]
  ds_read_b128 v[144:147], v10 offset:51200
  s_waitcnt lgkmcnt(6)
  v_mfma_f32_16x16x32_bf16 v[176:179], v[152:155], v[96:99], v[176:179]
  v_mfma_f32_16x16x32_bf16 v[180:183], v[152:155], v[100:103], v[180:183]
  ds_read_b128 v[148:151], v10 offset:52224
  s_waitcnt lgkmcnt(6)
  v_mfma_f32_16x16x32_bf16 v[184:187], v[156:159], v[96:99], v[184:187]
  v_mfma_f32_16x16x32_bf16 v[188:191], v[156:159], v[100:103], v[188:191]
  ds_read_b128 v[152:155], v11 offset:22528
  s_waitcnt lgkmcnt(6)
  v_mfma_f32_16x16x32_bf16 v[192:195], v[128:131], v[96:99], v[192:195]
  v_mfma_f32_16x16x32_bf16 v[196:199], v[128:131], v[100:103], v[196:199]
  ds_read_b128 v[156:159], v11 offset:23552
  s_waitcnt lgkmcnt(6)
  v_mfma_f32_16x16x32_bf16 v[200:203], v[132:135], v[96:99], v[200:203]
  v_mfma_f32_16x16x32_bf16 v[204:207], v[132:135], v[100:103], v[204:207]
  ds_read_b128 v[128:131], v10 offset:24576
  s_waitcnt vmcnt(5) lgkmcnt(6)
  v_mfma_f32_16x16x32_bf16 v[160:163], v[136:139], v[104:107], v[160:163]
  s_waitcnt vmcnt(4)
  v_mfma_f32_16x16x32_bf16 v[164:167], v[136:139], v[108:111], v[164:167]
  ds_read_b128 v[132:135], v10 offset:25600
  s_waitcnt lgkmcnt(6)
  v_mfma_f32_16x16x32_bf16 v[168:171], v[140:143], v[104:107], v[168:171]
  v_mfma_f32_16x16x32_bf16 v[172:175], v[140:143], v[108:111], v[172:175]
  ds_read_b128 v[136:139], v10 offset:53248
  s_waitcnt lgkmcnt(6)
  v_mfma_f32_16x16x32_bf16 v[176:179], v[144:147], v[104:107], v[176:179]
  v_mfma_f32_16x16x32_bf16 v[180:183], v[144:147], v[108:111], v[180:183]
  ds_read_b128 v[140:143], v10 offset:54272
  s_waitcnt lgkmcnt(6)
  v_mfma_f32_16x16x32_bf16 v[184:187], v[148:151], v[104:107], v[184:187]
  v_mfma_f32_16x16x32_bf16 v[188:191], v[148:151], v[108:111], v[188:191]
  ds_read_b128 v[144:147], v11 offset:24576
  s_waitcnt lgkmcnt(6)
  v_mfma_f32_16x16x32_bf16 v[192:195], v[152:155], v[104:107], v[192:195]
  v_mfma_f32_16x16x32_bf16 v[196:199], v[152:155], v[108:111], v[196:199]
  ds_read_b128 v[148:151], v11 offset:25600
  s_waitcnt lgkmcnt(6)
  v_mfma_f32_16x16x32_bf16 v[200:203], v[156:159], v[104:107], v[200:203]
  v_mfma_f32_16x16x32_bf16 v[204:207], v[156:159], v[108:111], v[204:207]
  ds_read_b128 v[152:155], v10 offset:26624
  s_waitcnt vmcnt(3) lgkmcnt(6)
  v_mfma_f32_16x16x32_bf16 v[160:163], v[128:131], v[112:115], v[160:163]
  s_waitcnt vmcnt(2)
  v_mfma_f32_16x16x32_bf16 v[164:167], v[128:131], v[116:119], v[164:167]
  ds_read_b128 v[156:159], v10 offset:27648
  s_waitcnt lgkmcnt(6)
  v_mfma_f32_16x16x32_bf16 v[168:171], v[132:135], v[112:115], v[168:171]
  v_mfma_f32_16x16x32_bf16 v[172:175], v[132:135], v[116:119], v[172:175]
  ds_read_b128 v[128:131], v10 offset:55296
  s_waitcnt lgkmcnt(6)
  v_mfma_f32_16x16x32_bf16 v[176:179], v[136:139], v[112:115], v[176:179]
  v_mfma_f32_16x16x32_bf16 v[180:183], v[136:139], v[116:119], v[180:183]
  ds_read_b128 v[132:135], v10 offset:56320
  s_waitcnt lgkmcnt(6)
  v_mfma_f32_16x16x32_bf16 v[184:187], v[140:143], v[112:115], v[184:187]
  v_mfma_f32_16x16x32_bf16 v[188:191], v[140:143], v[116:119], v[188:191]
  ds_read_b128 v[136:139], v11 offset:26624
  s_waitcnt lgkmcnt(6)
  v_mfma_f32_16x16x32_bf16 v[192:195], v[144:147], v[112:115], v[192:195]
  v_mfma_f32_16x16x32_bf16 v[196:199], v[144:147], v[116:119], v[196:199]
  ds_read_b128 v[140:143], v11 offset:27648
  s_waitcnt lgkmcnt(6)
  v_mfma_f32_16x16x32_bf16 v[200:203], v[148:151], v[112:115], v[200:203]
  v_mfma_f32_16x16x32_bf16 v[204:207], v[148:151], v[116:119], v[204:207]
  ds_read_b128 v[144:147], v11 offset:28672
  s_waitcnt vmcnt(1) lgkmcnt(6)
  v_mfma_f32_16x16x32_bf16 v[160:163], v[152:155], v[120:123], v[160:163]
  s_waitcnt vmcnt(0)
  v_mfma_f32_16x16x32_bf16 v[164:167], v[152:155], v[124:127], v[164:167]
  ds_read_b128 v[148:151], v11 offset:29696
  s_waitcnt lgkmcnt(6)
  v_mfma_f32_16x16x32_bf16 v[168:171], v[156:159], v[120:123], v[168:171]
  v_mfma_f32_16x16x32_bf16 v[172:175], v[156:159], v[124:127], v[172:175]
  ds_read_b128 v[152:155], v11 offset:30720
  s_waitcnt lgkmcnt(6)
  v_mfma_f32_16x16x32_bf16 v[176:179], v[128:131], v[120:123], v[176:179]
  v_mfma_f32_16x16x32_bf16 v[180:183], v[128:131], v[124:127], v[180:183]
  ds_read_b128 v[156:159], v11 offset:31744
  s_waitcnt lgkmcnt(6)
  v_mfma_f32_16x16x32_bf16 v[184:187], v[132:135], v[120:123], v[184:187]
  v_mfma_f32_16x16x32_bf16 v[188:191], v[132:135], v[124:127], v[188:191]
  ds_read_b128 v[128:131], v11 offset:32768
  s_waitcnt lgkmcnt(6)
  v_mfma_f32_16x16x32_bf16 v[192:195], v[136:139], v[120:123], v[192:195]
  v_mfma_f32_16x16x32_bf16 v[196:199], v[136:139], v[124:127], v[196:199]
  ds_read_b128 v[132:135], v11 offset:33792
  s_waitcnt lgkmcnt(6)
  v_mfma_f32_16x16x32_bf16 v[200:203], v[140:143], v[120:123], v[200:203]
  v_mfma_f32_16x16x32_bf16 v[204:207], v[140:143], v[124:127], v[204:207]
  s_barrier
  ds_read_b128 v[136:139], v11 offset:34816
  s_waitcnt lgkmcnt(6)
  v_mfma_f32_16x16x32_bf16 v[208:211], v[144:147], v[16:19], 0
  v_mfma_f32_16x16x32_bf16 v[212:215], v[144:147], v[20:23], 0
  ds_read_b128 v[140:143], v11 offset:35840
  s_waitcnt lgkmcnt(6)
  v_mfma_f32_16x16x32_bf16 v[216:219], v[148:151], v[16:19], 0
  v_mfma_f32_16x16x32_bf16 v[220:223], v[148:151], v[20:23], 0
  ds_read_b128 v[144:147], v11 offset:36864
  s_waitcnt lgkmcnt(6)
  v_mfma_f32_16x16x32_bf16 v[208:211], v[152:155], v[24:27], v[208:211]
  v_max_f32 v160, 0, v160
  v_max_f32 v161, 0, v161
  v_mfma_f32_16x16x32_bf16 v[212:215], v[152:155], v[28:31], v[212:215]
  v_max_f32 v162, 0, v162
  ds_read_b128 v[148:151], v11 offset:37888
  s_waitcnt lgkmcnt(6)
  v_mfma_f32_16x16x32_bf16 v[216:219], v[156:159], v[24:27], v[216:219]
  v_max_f32 v163, 0, v163
  v_max_f32 v164, 0, v164
  v_mfma_f32_16x16x32_bf16 v[220:223], v[156:159], v[28:31], v[220:223]
  v_max_f32 v165, 0, v165
  ds_read_b128 v[152:155], v11 offset:38912
  s_waitcnt lgkmcnt(6)
  v_mfma_f32_16x16x32_bf16 v[208:211], v[128:131], v[32:35], v[208:211]
  v_max_f32 v166, 0, v166
  v_max_f32 v167, 0, v167
  v_mfma_f32_16x16x32_bf16 v[212:215], v[128:131], v[36:39], v[212:215]
  v_pk_mul_f32 v[160:161], v[160:161], v[168:169]
  ds_read_b128 v[156:159], v11 offset:39936
  s_waitcnt lgkmcnt(6)
  v_mfma_f32_16x16x32_bf16 v[216:219], v[132:135], v[32:35], v[216:219]
  v_pk_mul_f32 v[162:163], v[162:163], v[170:171]
  v_pk_mul_f32 v[164:165], v[164:165], v[172:173]
  v_mfma_f32_16x16x32_bf16 v[220:223], v[132:135], v[36:39], v[220:223]
  v_pk_mul_f32 v[166:167], v[166:167], v[174:175]
  ds_read_b128 v[128:131], v11 offset:40960
  s_waitcnt lgkmcnt(6)
  v_mfma_f32_16x16x32_bf16 v[208:211], v[136:139], v[40:43], v[208:211]
  v_cvt_pk_bf16_f32 v224, v160, v161
  v_cvt_pk_bf16_f32 v226, v164, v165
  v_mfma_f32_16x16x32_bf16 v[212:215], v[136:139], v[44:47], v[212:215]
  v_cvt_pk_bf16_f32 v225, v162, v163
  ds_read_b128 v[132:135], v11 offset:41984
  s_waitcnt lgkmcnt(6)
  v_mfma_f32_16x16x32_bf16 v[216:219], v[140:143], v[40:43], v[216:219]
  v_cvt_pk_bf16_f32 v227, v166, v167
  v_mfma_f32_16x16x32_bf16 v[220:223], v[140:143], v[44:47], v[220:223]
  v_permlane16_swap_b32 v224, v226
  ds_read_b128 v[136:139], v11 offset:43008
  s_waitcnt lgkmcnt(6)
  v_mfma_f32_16x16x32_bf16 v[208:211], v[144:147], v[48:51], v[208:211]
  v_permlane16_swap_b32 v225, v227
  v_mfma_f32_16x16x32_bf16 v[212:215], v[144:147], v[52:55], v[212:215]
  buffer_store_dwordx4 v[224:227], v2, s[24:27], s74 offen offset:0 sc1
  ds_read_b128 v[140:143], v11 offset:44032
  s_waitcnt lgkmcnt(6)
  v_mfma_f32_16x16x32_bf16 v[216:219], v[148:151], v[48:51], v[216:219]
  v_max_f32 v176, 0, v176
  v_max_f32 v177, 0, v177
  v_mfma_f32_16x16x32_bf16 v[220:223], v[148:151], v[52:55], v[220:223]
  v_max_f32 v178, 0, v178
  ds_read_b128 v[144:147], v11 offset:45056
  s_waitcnt lgkmcnt(6)
  v_mfma_f32_16x16x32_bf16 v[208:211], v[152:155], v[56:59], v[208:211]
  v_max_f32 v179, 0, v179
  v_max_f32 v180, 0, v180
  v_mfma_f32_16x16x32_bf16 v[212:215], v[152:155], v[60:63], v[212:215]
  v_max_f32 v181, 0, v181
  ds_read_b128 v[148:151], v11 offset:46080
  s_waitcnt lgkmcnt(6)
  v_mfma_f32_16x16x32_bf16 v[216:219], v[156:159], v[56:59], v[216:219]
  v_max_f32 v182, 0, v182
  v_max_f32 v183, 0, v183
  v_mfma_f32_16x16x32_bf16 v[220:223], v[156:159], v[60:63], v[220:223]
  v_pk_mul_f32 v[176:177], v[176:177], v[184:185]
  ds_read_b128 v[152:155], v11 offset:47104
  s_waitcnt lgkmcnt(6)
  v_mfma_f32_16x16x32_bf16 v[208:211], v[128:131], v[64:67], v[208:211]
  v_pk_mul_f32 v[178:179], v[178:179], v[186:187]
  v_pk_mul_f32 v[180:181], v[180:181], v[188:189]
  v_mfma_f32_16x16x32_bf16 v[212:215], v[128:131], v[68:71], v[212:215]
  v_pk_mul_f32 v[182:183], v[182:183], v[190:191]
  ds_read_b128 v[156:159], v11 offset:48128
  s_waitcnt lgkmcnt(6)
  v_mfma_f32_16x16x32_bf16 v[216:219], v[132:135], v[64:67], v[216:219]
  v_cvt_pk_bf16_f32 v228, v176, v177
  v_cvt_pk_bf16_f32 v230, v180, v181
  v_mfma_f32_16x16x32_bf16 v[220:223], v[132:135], v[68:71], v[220:223]
  v_cvt_pk_bf16_f32 v229, v178, v179
  ds_read_b128 v[128:131], v11 offset:49152
  s_waitcnt lgkmcnt(6)
  v_mfma_f32_16x16x32_bf16 v[208:211], v[136:139], v[72:75], v[208:211]
  v_cvt_pk_bf16_f32 v231, v182, v183
  v_mfma_f32_16x16x32_bf16 v[212:215], v[136:139], v[76:79], v[212:215]
  v_permlane16_swap_b32 v228, v230
  ds_read_b128 v[132:135], v11 offset:50176
  s_waitcnt lgkmcnt(6)
  v_mfma_f32_16x16x32_bf16 v[216:219], v[140:143], v[72:75], v[216:219]
  v_permlane16_swap_b32 v229, v231
  v_mfma_f32_16x16x32_bf16 v[220:223], v[140:143], v[76:79], v[220:223]
  buffer_store_dwordx4 v[228:231], v2, s[24:27], s74 offen offset:1024 sc1
  ds_read_b128 v[136:139], v11 offset:51200
  s_waitcnt lgkmcnt(6)
  v_mfma_f32_16x16x32_bf16 v[208:211], v[144:147], v[80:83], v[208:211]
  v_max_f32 v192, 0, v192
  v_max_f32 v193, 0, v193
  v_mfma_f32_16x16x32_bf16 v[212:215], v[144:147], v[84:87], v[212:215]
  v_max_f32 v194, 0, v194
  ds_read_b128 v[140:143], v11 offset:52224
  s_waitcnt lgkmcnt(6)
  v_mfma_f32_16x16x32_bf16 v[216:219], v[148:151], v[80:83], v[216:219]
  v_max_f32 v195, 0, v195
  v_max_f32 v196, 0, v196
  v_mfma_f32_16x16x32_bf16 v[220:223], v[148:151], v[84:87], v[220:223]
  v_max_f32 v197, 0, v197
  ds_read_b128 v[144:147], v11 offset:53248
  s_waitcnt lgkmcnt(6)
  v_mfma_f32_16x16x32_bf16 v[208:211], v[152:155], v[88:91], v[208:211]
  v_max_f32 v198, 0, v198
  v_max_f32 v199, 0, v199
  v_mfma_f32_16x16x32_bf16 v[212:215], v[152:155], v[92:95], v[212:215]
  v_pk_mul_f32 v[192:193], v[192:193], v[200:201]
  ds_read_b128 v[148:151], v11 offset:54272
  s_waitcnt lgkmcnt(6)
  v_mfma_f32_16x16x32_bf16 v[216:219], v[156:159], v[88:91], v[216:219]
  v_pk_mul_f32 v[194:195], v[194:195], v[202:203]
  v_pk_mul_f32 v[196:197], v[196:197], v[204:205]
  v_mfma_f32_16x16x32_bf16 v[220:223], v[156:159], v[92:95], v[220:223]
  v_pk_mul_f32 v[198:199], v[198:199], v[206:207]
  ds_read_b128 v[152:155], v11 offset:55296
  s_waitcnt lgkmcnt(6)
  v_mfma_f32_16x16x32_bf16 v[208:211], v[128:131], v[96:99], v[208:211]
  v_cvt_pk_bf16_f32 v224, v192, v193
  v_cvt_pk_bf16_f32 v226, v196, v197
  v_mfma_f32_16x16x32_bf16 v[212:215], v[128:131], v[100:103], v[212:215]
  v_cvt_pk_bf16_f32 v225, v194, v195
  ds_read_b128 v[156:159], v11 offset:56320
  s_waitcnt lgkmcnt(6)
  v_mfma_f32_16x16x32_bf16 v[216:219], v[132:135], v[96:99], v[216:219]
  v_cvt_pk_bf16_f32 v227, v198, v199
  v_mfma_f32_16x16x32_bf16 v[220:223], v[132:135], v[100:103], v[220:223]
  v_permlane16_swap_b32 v224, v226
  ds_read_b128 v[128:131], v12 offset:0
  s_waitcnt lgkmcnt(6)
  v_mfma_f32_16x16x32_bf16 v[208:211], v[136:139], v[104:107], v[208:211]
  v_permlane16_swap_b32 v225, v227
  v_mfma_f32_16x16x32_bf16 v[212:215], v[136:139], v[108:111], v[212:215]
  buffer_store_dwordx4 v[224:227], v2, s[24:27], s74 offen offset:2048 sc1
  ds_read_b128 v[132:135], v12 offset:1024
  s_waitcnt lgkmcnt(6)
  v_mfma_f32_16x16x32_bf16 v[216:219], v[140:143], v[104:107], v[216:219]
  v_mfma_f32_16x16x32_bf16 v[220:223], v[140:143], v[108:111], v[220:223]
  ds_read_b128 v[136:139], v12 offset:2048
  s_waitcnt lgkmcnt(6)
  v_mfma_f32_16x16x32_bf16 v[208:211], v[144:147], v[112:115], v[208:211]
  v_mfma_f32_16x16x32_bf16 v[212:215], v[144:147], v[116:119], v[212:215]
  ds_read_b128 v[140:143], v12 offset:3072
  s_waitcnt lgkmcnt(6)
  v_mfma_f32_16x16x32_bf16 v[216:219], v[148:151], v[112:115], v[216:219]
  v_mfma_f32_16x16x32_bf16 v[220:223], v[148:151], v[116:119], v[220:223]
  ds_read_b128 v[144:147], v12 offset:4096
  s_waitcnt lgkmcnt(6)
  v_mfma_f32_16x16x32_bf16 v[208:211], v[152:155], v[120:123], v[208:211]
  v_mfma_f32_16x16x32_bf16 v[212:215], v[152:155], v[124:127], v[212:215]
  ds_read_b128 v[148:151], v12 offset:5120
  s_waitcnt lgkmcnt(6)
  v_mfma_f32_16x16x32_bf16 v[216:219], v[156:159], v[120:123], v[216:219]
  v_mfma_f32_16x16x32_bf16 v[220:223], v[156:159], v[124:127], v[220:223]
  ds_read_b128 v[152:155], v12 offset:6144
  s_waitcnt lgkmcnt(6)
  v_mfma_f32_16x16x32_bf16 v[160:163], v[128:131], v[16:19], 0
  v_mfma_f32_16x16x32_bf16 v[164:167], v[128:131], v[20:23], 0
  ds_read_b128 v[156:159], v12 offset:7168
  s_waitcnt lgkmcnt(6)
  v_mfma_f32_16x16x32_bf16 v[168:171], v[132:135], v[16:19], 0
  v_mfma_f32_16x16x32_bf16 v[172:175], v[132:135], v[20:23], 0
  ds_read_b128 v[128:131], v12 offset:8192
  s_waitcnt lgkmcnt(6)
  v_mfma_f32_16x16x32_bf16 v[160:163], v[136:139], v[24:27], v[160:163]
  v_max_f32 v208, 0, v208
  v_max_f32 v209, 0, v209
  v_mfma_f32_16x16x32_bf16 v[164:167], v[136:139], v[28:31], v[164:167]
  v_max_f32 v210, 0, v210
  ds_read_b128 v[132:135], v12 offset:9216
  s_waitcnt lgkmcnt(6)
  v_mfma_f32_16x16x32_bf16 v[168:171], v[140:143], v[24:27], v[168:171]
  v_max_f32 v211, 0, v211
  v_max_f32 v212, 0, v212
  v_mfma_f32_16x16x32_bf16 v[172:175], v[140:143], v[28:31], v[172:175]
  v_max_f32 v213, 0, v213
  ds_read_b128 v[136:139], v12 offset:10240
  s_waitcnt lgkmcnt(6)
  v_mfma_f32_16x16x32_bf16 v[160:163], v[144:147], v[32:35], v[160:163]
  v_max_f32 v214, 0, v214
  v_max_f32 v215, 0, v215
  v_mfma_f32_16x16x32_bf16 v[164:167], v[144:147], v[36:39], v[164:167]
  v_pk_mul_f32 v[208:209], v[208:209], v[216:217]
  ds_read_b128 v[140:143], v12 offset:11264
  s_waitcnt lgkmcnt(6)
  v_mfma_f32_16x16x32_bf16 v[168:171], v[148:151], v[32:35], v[168:171]
  v_pk_mul_f32 v[210:211], v[210:211], v[218:219]
  v_pk_mul_f32 v[212:213], v[212:213], v[220:221]
  v_mfma_f32_16x16x32_bf16 v[172:175], v[148:151], v[36:39], v[172:175]
  v_pk_mul_f32 v[214:215], v[214:215], v[222:223]
  ds_read_b128 v[144:147], v12 offset:12288
  s_waitcnt lgkmcnt(6)
  v_mfma_f32_16x16x32_bf16 v[160:163], v[152:155], v[40:43], v[160:163]
  v_cvt_pk_bf16_f32 v228, v208, v209
  v_cvt_pk_bf16_f32 v230, v212, v213
  v_mfma_f32_16x16x32_bf16 v[164:167], v[152:155], v[44:47], v[164:167]
  v_cvt_pk_bf16_f32 v229, v210, v211
  ds_read_b128 v[148:151], v12 offset:13312
  s_waitcnt lgkmcnt(6)
  v_mfma_f32_16x16x32_bf16 v[168:171], v[156:159], v[40:43], v[168:171]
  v_cvt_pk_bf16_f32 v231, v214, v215
  v_mfma_f32_16x16x32_bf16 v[172:175], v[156:159], v[44:47], v[172:175]
  v_permlane16_swap_b32 v228, v230
  ds_read_b128 v[152:155], v12 offset:14336
  s_waitcnt lgkmcnt(6)
  v_mfma_f32_16x16x32_bf16 v[160:163], v[128:131], v[48:51], v[160:163]
  v_permlane16_swap_b32 v229, v231
  v_mfma_f32_16x16x32_bf16 v[164:167], v[128:131], v[52:55], v[164:167]
  buffer_store_dwordx4 v[228:231], v2, s[24:27], s74 offen offset:3072 sc1
  ds_read_b128 v[156:159], v12 offset:15360
  s_waitcnt lgkmcnt(6)
  v_mfma_f32_16x16x32_bf16 v[168:171], v[132:135], v[48:51], v[168:171]
  v_mfma_f32_16x16x32_bf16 v[172:175], v[132:135], v[52:55], v[172:175]
  ds_read_b128 v[128:131], v12 offset:16384
  s_waitcnt lgkmcnt(6)
  v_mfma_f32_16x16x32_bf16 v[160:163], v[136:139], v[56:59], v[160:163]
  v_mfma_f32_16x16x32_bf16 v[164:167], v[136:139], v[60:63], v[164:167]
  ds_read_b128 v[132:135], v12 offset:17408
  s_waitcnt lgkmcnt(6)
  v_mfma_f32_16x16x32_bf16 v[168:171], v[140:143], v[56:59], v[168:171]
  v_mfma_f32_16x16x32_bf16 v[172:175], v[140:143], v[60:63], v[172:175]
  ds_read_b128 v[136:139], v12 offset:18432
  s_waitcnt lgkmcnt(6)
  v_mfma_f32_16x16x32_bf16 v[160:163], v[144:147], v[64:67], v[160:163]
  v_mfma_f32_16x16x32_bf16 v[164:167], v[144:147], v[68:71], v[164:167]
  ds_read_b128 v[140:143], v12 offset:19456
  s_waitcnt lgkmcnt(6)
  v_mfma_f32_16x16x32_bf16 v[168:171], v[148:151], v[64:67], v[168:171]
  v_mfma_f32_16x16x32_bf16 v[172:175], v[148:151], v[68:71], v[172:175]
  ds_read_b128 v[144:147], v12 offset:20480
  s_waitcnt lgkmcnt(6)
  v_mfma_f32_16x16x32_bf16 v[160:163], v[152:155], v[72:75], v[160:163]
  v_mfma_f32_16x16x32_bf16 v[164:167], v[152:155], v[76:79], v[164:167]
  ds_read_b128 v[148:151], v12 offset:21504
  s_waitcnt lgkmcnt(6)
  v_mfma_f32_16x16x32_bf16 v[168:171], v[156:159], v[72:75], v[168:171]
  v_mfma_f32_16x16x32_bf16 v[172:175], v[156:159], v[76:79], v[172:175]
  ds_read_b128 v[152:155], v12 offset:22528
  s_waitcnt lgkmcnt(6)
  v_mfma_f32_16x16x32_bf16 v[160:163], v[128:131], v[80:83], v[160:163]
  v_mfma_f32_16x16x32_bf16 v[164:167], v[128:131], v[84:87], v[164:167]
  ds_read_b128 v[156:159], v12 offset:23552
  s_waitcnt lgkmcnt(6)
  v_mfma_f32_16x16x32_bf16 v[168:171], v[132:135], v[80:83], v[168:171]
  v_mfma_f32_16x16x32_bf16 v[172:175], v[132:135], v[84:87], v[172:175]
  ds_read_b128 v[128:131], v12 offset:24576
  s_waitcnt lgkmcnt(6)
  v_mfma_f32_16x16x32_bf16 v[160:163], v[136:139], v[88:91], v[160:163]
  v_mfma_f32_16x16x32_bf16 v[164:167], v[136:139], v[92:95], v[164:167]
  ds_read_b128 v[132:135], v12 offset:25600
  s_waitcnt lgkmcnt(6)
  v_mfma_f32_16x16x32_bf16 v[168:171], v[140:143], v[88:91], v[168:171]
  v_mfma_f32_16x16x32_bf16 v[172:175], v[140:143], v[92:95], v[172:175]
  ds_read_b128 v[136:139], v12 offset:26624
  s_waitcnt lgkmcnt(6)
  v_mfma_f32_16x16x32_bf16 v[160:163], v[144:147], v[96:99], v[160:163]
  v_mfma_f32_16x16x32_bf16 v[164:167], v[144:147], v[100:103], v[164:167]
  ds_read_b128 v[140:143], v12 offset:27648
  s_waitcnt lgkmcnt(6)
  v_mfma_f32_16x16x32_bf16 v[168:171], v[148:151], v[96:99], v[168:171]
  v_or_b32 v14, 1, v3
  s_waitcnt vmcnt(2)
  s_mov_b64 exec, 1
  s_cmp_eq_u32 s61, 0
  s_cbranch_scc1 Lnl_18
  buffer_store_dword v14, off, s[24:27], s71
Lnle_19:
  s_mov_b64 exec, -1
  v_mfma_f32_16x16x32_bf16 v[172:175], v[148:151], v[100:103], v[172:175]
  s_barrier
  ds_read_b128 v[144:147], v10 offset:0
  s_waitcnt lgkmcnt(6)
  v_mfma_f32_16x16x32_bf16 v[160:163], v[152:155], v[104:107], v[160:163]
  v_mfma_f32_16x16x32_bf16 v[164:167], v[152:155], v[108:111], v[164:167]
  ds_read_b128 v[148:151], v10 offset:1024
  s_waitcnt lgkmcnt(6)
  v_mfma_f32_16x16x32_bf16 v[168:171], v[156:159], v[104:107], v[168:171]
  v_mfma_f32_16x16x32_bf16 v[172:175], v[156:159], v[108:111], v[172:175]
  ds_read_b128 v[152:155], v10 offset:2048
  s_waitcnt lgkmcnt(6)
  v_mfma_f32_16x16x32_bf16 v[160:163], v[128:131], v[112:115], v[160:163]
  v_mfma_f32_16x16x32_bf16 v[164:167], v[128:131], v[116:119], v[164:167]
  ds_read_b128 v[156:159], v10 offset:3072
  s_waitcnt lgkmcnt(6)
  v_mfma_f32_16x16x32_bf16 v[168:171], v[132:135], v[112:115], v[168:171]
  v_mfma_f32_16x16x32_bf16 v[172:175], v[132:135], v[116:119], v[172:175]
  ds_read_b128 v[128:131], v10 offset:4096
  s_waitcnt lgkmcnt(6)
  v_mfma_f32_16x16x32_bf16 v[160:163], v[136:139], v[120:123], v[160:163]
  v_mfma_f32_16x16x32_bf16 v[164:167], v[136:139], v[124:127], v[164:167]
  ds_read_b128 v[132:135], v10 offset:5120
  s_waitcnt lgkmcnt(6)
  v_mfma_f32_16x16x32_bf16 v[168:171], v[140:143], v[120:123], v[168:171]
  v_mfma_f32_16x16x32_bf16 v[172:175], v[140:143], v[124:127], v[172:175]
  ds_read_b128 v[136:139], v10 offset:6144
  s_waitcnt lgkmcnt(6)
  v_mfma_f32_16x16x32_bf16 v[176:179], v[144:147], v[16:19], 0
  v_mfma_f32_16x16x32_bf16 v[180:183], v[144:147], v[20:23], 0
  ds_read_b128 v[140:143], v10 offset:7168
  s_waitcnt lgkmcnt(6)
  v_mfma_f32_16x16x32_bf16 v[184:187], v[148:151], v[16:19], 0
  v_mfma_f32_16x16x32_bf16 v[188:191], v[148:151], v[20:23], 0
  ds_read_b128 v[144:147], v10 offset:8192
  s_waitcnt lgkmcnt(6)
  v_mfma_f32_16x16x32_bf16 v[176:179], v[152:155], v[24:27], v[176:179]
  v_max_f32 v160, 0, v160
  v_max_f32 v161, 0, v161
  v_mfma_f32_16x16x32_bf16 v[180:183], v[152:155], v[28:31], v[180:183]
  v_max_f32 v162, 0, v162
  ds_read_b128 v[148:151], v10 offset:9216
  s_waitcnt lgkmcnt(6)
  v_mfma_f32_16x16x32_bf16 v[184:187], v[156:159], v[24:27], v[184:187]
  v_max_f32 v163, 0, v163
  v_max_f32 v164, 0, v164
  v_mfma_f32_16x16x32_bf16 v[188:191], v[156:159], v[28:31], v[188:191]
  v_max_f32 v165, 0, v165
  ds_read_b128 v[152:155], v10 offset:10240
  s_waitcnt lgkmcnt(6)
  v_mfma_f32_16x16x32_bf16 v[176:179], v[128:131], v[32:35], v[176:179]
  v_max_f32 v166, 0, v166
  v_max_f32 v167, 0, v167
  v_mfma_f32_16x16x32_bf16 v[180:183], v[128:131], v[36:39], v[180:183]
  v_pk_mul_f32 v[160:161], v[160:161], v[168:169]
  ds_read_b128 v[156:159], v10 offset:11264
  s_waitcnt lgkmcnt(6)
  v_mfma_f32_16x16x32_bf16 v[184:187], v[132:135], v[32:35], v[184:187]
  v_pk_mul_f32 v[162:163], v[162:163], v[170:171]
  v_pk_mul_f32 v[164:165], v[164:165], v[172:173]
  v_mfma_f32_16x16x32_bf16 v[188:191], v[132:135], v[36:39], v[188:191]
  v_pk_mul_f32 v[166:167], v[166:167], v[174:175]
  ds_read_b128 v[128:131], v10 offset:12288
  s_waitcnt lgkmcnt(6)
  v_mfma_f32_16x16x32_bf16 v[176:179], v[136:139], v[40:43], v[176:179]
  v_cvt_pk_bf16_f32 v224, v160, v161
  v_cvt_pk_bf16_f32 v226, v164, v165
  v_mfma_f32_16x16x32_bf16 v[180:183], v[136:139], v[44:47], v[180:183]
  v_cvt_pk_bf16_f32 v225, v162, v163
  v_or_b32 v14, 2, v3
  s_waitcnt vmcnt(1)
  s_mov_b64 exec, 1
  s_cmp_eq_u32 s61, 0
  s_cbranch_scc1 Lnl_20
  buffer_store_dword v14, off, s[24:27], s71
Lnle_21:
  s_mov_b64 exec, -1
  ds_read_b128 v[132:135], v10 offset:13312
  s_waitcnt lgkmcnt(6)
  v_mfma_f32_16x16x32_bf16 v[184:187], v[140:143], v[40:43], v[184:187]
  v_cvt_pk_bf16_f32 v227, v166, v167
  v_mfma_f32_16x16x32_bf16 v[188:191], v[140:143], v[44:47], v[188:191]
  v_permlane16_swap_b32 v224, v226
  ds_read_b128 v[136:139], v10 offset:14336
  s_waitcnt lgkmcnt(6)
  v_mfma_f32_16x16x32_bf16 v[176:179], v[144:147], v[48:51], v[176:179]
  v_permlane16_swap_b32 v225, v227
  v_mfma_f32_16x16x32_bf16 v[180:183], v[144:147], v[52:55], v[180:183]
  buffer_store_dwordx4 v[224:227], v2, s[24:27], s75 offen offset:0 sc1
  ds_read_b128 v[140:143], v10 offset:15360
  s_waitcnt lgkmcnt(6)
  v_mfma_f32_16x16x32_bf16 v[184:187], v[148:151], v[48:51], v[184:187]
  v_mfma_f32_16x16x32_bf16 v[188:191], v[148:151], v[52:55], v[188:191]
  ds_read_b128 v[144:147], v10 offset:16384
  s_waitcnt lgkmcnt(6)
  v_mfma_f32_16x16x32_bf16 v[176:179], v[152:155], v[56:59], v[176:179]
  v_mfma_f32_16x16x32_bf16 v[180:183], v[152:155], v[60:63], v[180:183]
  ds_read_b128 v[148:151], v10 offset:17408
  s_waitcnt lgkmcnt(6)
  v_mfma_f32_16x16x32_bf16 v[184:187], v[156:159], v[56:59], v[184:187]
  v_mfma_f32_16x16x32_bf16 v[188:191], v[156:159], v[60:63], v[188:191]
  ds_read_b128 v[152:155], v10 offset:18432
  s_waitcnt lgkmcnt(6)
  v_mfma_f32_16x16x32_bf16 v[176:179], v[128:131], v[64:67], v[176:179]
  v_mfma_f32_16x16x32_bf16 v[180:183], v[128:131], v[68:71], v[180:183]
  ds_read_b128 v[156:159], v10 offset:19456
  s_waitcnt lgkmcnt(6)
  v_mfma_f32_16x16x32_bf16 v[184:187], v[132:135], v[64:67], v[184:187]
  v_mfma_f32_16x16x32_bf16 v[188:191], v[132:135], v[68:71], v[188:191]
  ds_read_b128 v[128:131], v10 offset:20480
  s_waitcnt lgkmcnt(6)
  v_mfma_f32_16x16x32_bf16 v[176:179], v[136:139], v[72:75], v[176:179]
  v_mfma_f32_16x16x32_bf16 v[180:183], v[136:139], v[76:79], v[180:183]
  ds_read_b128 v[132:135], v10 offset:21504
  s_waitcnt lgkmcnt(6)
  v_mfma_f32_16x16x32_bf16 v[184:187], v[140:143], v[72:75], v[184:187]
  v_mfma_f32_16x16x32_bf16 v[188:191], v[140:143], v[76:79], v[188:191]
  ds_read_b128 v[136:139], v10 offset:22528
  s_waitcnt lgkmcnt(6)
  v_mfma_f32_16x16x32_bf16 v[176:179], v[144:147], v[80:83], v[176:179]
  v_mfma_f32_16x16x32_bf16 v[180:183], v[144:147], v[84:87], v[180:183]
  ds_read_b128 v[140:143], v10 offset:23552
  s_waitcnt lgkmcnt(6)
  v_mfma_f32_16x16x32_bf16 v[184:187], v[148:151], v[80:83], v[184:187]
  v_mfma_f32_16x16x32_bf16 v[188:191], v[148:151], v[84:87], v[188:191]
  ds_read_b128 v[144:147], v10 offset:24576
  s_waitcnt lgkmcnt(6)
  v_mfma_f32_16x16x32_bf16 v[176:179], v[152:155], v[88:91], v[176:179]
  v_mfma_f32_16x16x32_bf16 v[180:183], v[152:155], v[92:95], v[180:183]
  ds_read_b128 v[148:151], v10 offset:25600
  s_waitcnt lgkmcnt(6)
  v_mfma_f32_16x16x32_bf16 v[184:187], v[156:159], v[88:91], v[184:187]
  v_mfma_f32_16x16x32_bf16 v[188:191], v[156:159], v[92:95], v[188:191]
  ds_read_b128 v[152:155], v10 offset:26624
  s_waitcnt lgkmcnt(6)
  v_mfma_f32_16x16x32_bf16 v[176:179], v[128:131], v[96:99], v[176:179]
  v_mfma_f32_16x16x32_bf16 v[180:183], v[128:131], v[100:103], v[180:183]
  ds_read_b128 v[156:159], v10 offset:27648
  s_waitcnt lgkmcnt(6)
  v_mfma_f32_16x16x32_bf16 v[184:187], v[132:135], v[96:99], v[184:187]
  v_mfma_f32_16x16x32_bf16 v[188:191], v[132:135], v[100:103], v[188:191]
  ds_read_b128 v[128:131], v10 offset:28672
  s_waitcnt lgkmcnt(6)
  v_mfma_f32_16x16x32_bf16 v[176:179], v[136:139], v[104:107], v[176:179]
  v_mfma_f32_16x16x32_bf16 v[180:183], v[136:139], v[108:111], v[180:183]
  ds_read_b128 v[132:135], v10 offset:29696
  s_waitcnt lgkmcnt(6)
  v_mfma_f32_16x16x32_bf16 v[184:187], v[140:143], v[104:107], v[184:187]
  v_mfma_f32_16x16x32_bf16 v[188:191], v[140:143], v[108:111], v[188:191]
  ds_read_b128 v[136:139], v10 offset:30720
  s_waitcnt lgkmcnt(6)
  v_mfma_f32_16x16x32_bf16 v[176:179], v[144:147], v[112:115], v[176:179]
  v_mfma_f32_16x16x32_bf16 v[180:183], v[144:147], v[116:119], v[180:183]
  ds_read_b128 v[140:143], v10 offset:31744
  s_waitcnt lgkmcnt(6)
  v_mfma_f32_16x16x32_bf16 v[184:187], v[148:151], v[112:115], v[184:187]
  v_mfma_f32_16x16x32_bf16 v[188:191], v[148:151], v[116:119], v[188:191]
  ds_read_b128 v[144:147], v10 offset:32768
  s_waitcnt lgkmcnt(6)
  v_mfma_f32_16x16x32_bf16 v[176:179], v[152:155], v[120:123], v[176:179]
  v_mfma_f32_16x16x32_bf16 v[180:183], v[152:155], v[124:127], v[180:183]
  ds_read_b128 v[148:151], v10 offset:33792
  s_waitcnt lgkmcnt(6)
  v_mfma_f32_16x16x32_bf16 v[184:187], v[156:159], v[120:123], v[184:187]
  v_mfma_f32_16x16x32_bf16 v[188:191], v[156:159], v[124:127], v[188:191]
  ds_read_b128 v[152:155], v10 offset:34816
  s_waitcnt lgkmcnt(6)
  v_mfma_f32_16x16x32_bf16 v[192:195], v[128:131], v[16:19], 0
  v_mfma_f32_16x16x32_bf16 v[196:199], v[128:131], v[20:23], 0
  ds_read_b128 v[156:159], v10 offset:35840
  s_waitcnt lgkmcnt(6)
  v_mfma_f32_16x16x32_bf16 v[200:203], v[132:135], v[16:19], 0
  v_mfma_f32_16x16x32_bf16 v[204:207], v[132:135], v[20:23], 0
  ds_read_b128 v[128:131], v10 offset:36864
  s_waitcnt lgkmcnt(6)
  v_mfma_f32_16x16x32_bf16 v[192:195], v[136:139], v[24:27], v[192:195]
  v_max_f32 v176, 0, v176
  v_max_f32 v177, 0, v177
  v_mfma_f32_16x16x32_bf16 v[196:199], v[136:139], v[28:31], v[196:199]
  v_max_f32 v178, 0, v178
  ds_read_b128 v[132:135], v10 offset:37888
  s_waitcnt lgkmcnt(6)
  v_mfma_f32_16x16x32_bf16 v[200:203], v[140:143], v[24:27], v[200:203]
  v_max_f32 v179, 0, v179
  v_max_f32 v180, 0, v180
  v_mfma_f32_16x16x32_bf16 v[204:207], v[140:143], v[28:31], v[204:207]
  v_max_f32 v181, 0, v181
  ds_read_b128 v[136:139], v10 offset:38912
  s_waitcnt lgkmcnt(6)
  v_mfma_f32_16x16x32_bf16 v[192:195], v[144:147], v[32:35], v[192:195]
  v_max_f32 v182, 0, v182
  v_max_f32 v183, 0, v183
  v_mfma_f32_16x16x32_bf16 v[196:199], v[144:147], v[36:39], v[196:199]
  v_pk_mul_f32 v[176:177], v[176:177], v[184:185]
  ds_read_b128 v[140:143], v10 offset:39936
  s_waitcnt lgkmcnt(6)
  v_mfma_f32_16x16x32_bf16 v[200:203], v[148:151], v[32:35], v[200:203]
  v_pk_mul_f32 v[178:179], v[178:179], v[186:187]
  v_pk_mul_f32 v[180:181], v[180:181], v[188:189]
  v_mfma_f32_16x16x32_bf16 v[204:207], v[148:151], v[36:39], v[204:207]
  v_pk_mul_f32 v[182:183], v[182:183], v[190:191]
  ds_read_b128 v[144:147], v10 offset:40960
  s_waitcnt lgkmcnt(6)
  v_mfma_f32_16x16x32_bf16 v[192:195], v[152:155], v[40:43], v[192:195]
  v_cvt_pk_bf16_f32 v228, v176, v177
  v_cvt_pk_bf16_f32 v230, v180, v181
  v_mfma_f32_16x16x32_bf16 v[196:199], v[152:155], v[44:47], v[196:199]
  v_cvt_pk_bf16_f32 v229, v178, v179
  ds_read_b128 v[148:151], v10 offset:41984
  s_waitcnt lgkmcnt(6)
  v_mfma_f32_16x16x32_bf16 v[200:203], v[156:159], v[40:43], v[200:203]
  v_cvt_pk_bf16_f32 v231, v182, v183
  v_mfma_f32_16x16x32_bf16 v[204:207], v[156:159], v[44:47], v[204:207]
  v_permlane16_swap_b32 v228, v230
  ds_read_b128 v[152:155], v10 offset:43008
  s_waitcnt lgkmcnt(6)
  v_mfma_f32_16x16x32_bf16 v[192:195], v[128:131], v[48:51], v[192:195]
  v_permlane16_swap_b32 v229, v231
  v_mfma_f32_16x16x32_bf16 v[196:199], v[128:131], v[52:55], v[196:199]
  buffer_store_dwordx4 v[228:231], v2, s[24:27], s76 offen offset:0 sc1
  ds_read_b128 v[156:159], v10 offset:44032
  s_waitcnt lgkmcnt(6)
  v_mfma_f32_16x16x32_bf16 v[200:203], v[132:135], v[48:51], v[200:203]
  v_mfma_f32_16x16x32_bf16 v[204:207], v[132:135], v[52:55], v[204:207]
  ds_read_b128 v[128:131], v10 offset:45056
  s_waitcnt lgkmcnt(6)
  v_mfma_f32_16x16x32_bf16 v[192:195], v[136:139], v[56:59], v[192:195]
  v_mfma_f32_16x16x32_bf16 v[196:199], v[136:139], v[60:63], v[196:199]
  ds_read_b128 v[132:135], v10 offset:46080
  s_waitcnt lgkmcnt(6)
  v_mfma_f32_16x16x32_bf16 v[200:203], v[140:143], v[56:59], v[200:203]
  v_mfma_f32_16x16x32_bf16 v[204:207], v[140:143], v[60:63], v[204:207]
  ds_read_b128 v[136:139], v10 offset:47104
  s_waitcnt lgkmcnt(6)
  v_mfma_f32_16x16x32_bf16 v[192:195], v[144:147], v[64:67], v[192:195]
  v_mfma_f32_16x16x32_bf16 v[196:199], v[144:147], v[68:71], v[196:199]
  ds_read_b128 v[140:143], v10 offset:48128
  s_waitcnt lgkmcnt(6)
  v_mfma_f32_16x16x32_bf16 v[200:203], v[148:151], v[64:67], v[200:203]
  v_mfma_f32_16x16x32_bf16 v[204:207], v[148:151], v[68:71], v[204:207]
  ds_read_b128 v[144:147], v10 offset:49152
  s_waitcnt lgkmcnt(6)
  v_mfma_f32_16x16x32_bf16 v[192:195], v[152:155], v[72:75], v[192:195]
  v_mfma_f32_16x16x32_bf16 v[196:199], v[152:155], v[76:79], v[196:199]
  ds_read_b128 v[148:151], v10 offset:50176
  s_waitcnt lgkmcnt(6)
  v_mfma_f32_16x16x32_bf16 v[200:203], v[156:159], v[72:75], v[200:203]
  v_mfma_f32_16x16x32_bf16 v[204:207], v[156:159], v[76:79], v[204:207]
  ds_read_b128 v[152:155], v10 offset:51200
  s_waitcnt lgkmcnt(6)
  v_mfma_f32_16x16x32_bf16 v[192:195], v[128:131], v[80:83], v[192:195]
  v_mfma_f32_16x16x32_bf16 v[196:199], v[128:131], v[84:87], v[196:199]
  ds_read_b128 v[156:159], v10 offset:52224
  s_waitcnt lgkmcnt(6)
  v_mfma_f32_16x16x32_bf16 v[200:203], v[132:135], v[80:83], v[200:203]
  v_mfma_f32_16x16x32_bf16 v[204:207], v[132:135], v[84:87], v[204:207]
  ds_read_b128 v[128:131], v10 offset:53248
  s_waitcnt lgkmcnt(6)
  v_mfma_f32_16x16x32_bf16 v[192:195], v[136:139], v[88:91], v[192:195]
  v_mfma_f32_16x16x32_bf16 v[196:199], v[136:139], v[92:95], v[196:199]
  ds_read_b128 v[132:135], v10 offset:54272
  s_waitcnt lgkmcnt(6)
  v_mfma_f32_16x16x32_bf16 v[200:203], v[140:143], v[88:91], v[200:203]
  v_mfma_f32_16x16x32_bf16 v[204:207], v[140:143], v[92:95], v[204:207]
  ds_read_b128 v[136:139], v10 offset:55296
  s_waitcnt lgkmcnt(6)
  v_mfma_f32_16x16x32_bf16 v[192:195], v[144:147], v[96:99], v[192:195]
  v_mfma_f32_16x16x32_bf16 v[196:199], v[144:147], v[100:103], v[196:199]
  ds_read_b128 v[140:143], v10 offset:56320
  s_waitcnt lgkmcnt(6)
  v_mfma_f32_16x16x32_bf16 v[200:203], v[148:151], v[96:99], v[200:203]
  v_mfma_f32_16x16x32_bf16 v[204:207], v[148:151], v[100:103], v[204:207]
  s_waitcnt lgkmcnt(5)
  v_mfma_f32_16x16x32_bf16 v[192:195], v[152:155], v[104:107], v[192:195]
  v_mfma_f32_16x16x32_bf16 v[196:199], v[152:155], v[108:111], v[196:199]
  s_waitcnt lgkmcnt(4)
  v_mfma_f32_16x16x32_bf16 v[200:203], v[156:159], v[104:107], v[200:203]
  v_mfma_f32_16x16x32_bf16 v[204:207], v[156:159], v[108:111], v[204:207]
  s_waitcnt lgkmcnt(3)
  v_mfma_f32_16x16x32_bf16 v[192:195], v[128:131], v[112:115], v[192:195]
  v_mfma_f32_16x16x32_bf16 v[196:199], v[128:131], v[116:119], v[196:199]
  s_waitcnt lgkmcnt(2)
  v_mfma_f32_16x16x32_bf16 v[200:203], v[132:135], v[112:115], v[200:203]
  v_mfma_f32_16x16x32_bf16 v[204:207], v[132:135], v[116:119], v[204:207]
  s_waitcnt lgkmcnt(1)
  v_mfma_f32_16x16x32_bf16 v[192:195], v[136:139], v[120:123], v[192:195]
  v_mfma_f32_16x16x32_bf16 v[196:199], v[136:139], v[124:127], v[196:199]
  s_waitcnt lgkmcnt(0)
  v_mfma_f32_16x16x32_bf16 v[200:203], v[140:143], v[120:123], v[200:203]
  v_mfma_f32_16x16x32_bf16 v[204:207], v[140:143], v[124:127], v[204:207]
  s_nop 3
  v_max_f32 v192, 0, v192
  v_max_f32 v193, 0, v193
  v_max_f32 v194, 0, v194
  v_max_f32 v195, 0, v195
  v_max_f32 v196, 0, v196
  v_max_f32 v197, 0, v197
  v_max_f32 v198, 0, v198
  v_max_f32 v199, 0, v199
  v_pk_mul_f32 v[192:193], v[192:193], v[200:201]
  v_pk_mul_f32 v[194:195], v[194:195], v[202:203]
  v_pk_mul_f32 v[196:197], v[196:197], v[204:205]
  v_pk_mul_f32 v[198:199], v[198:199], v[206:207]
  v_cvt_pk_bf16_f32 v224, v192, v193
  v_cvt_pk_bf16_f32 v226, v196, v197
  v_cvt_pk_bf16_f32 v225, v194, v195
  v_cvt_pk_bf16_f32 v227, v198, v199
  v_permlane16_swap_b32 v224, v226
  s_nop 0
  v_permlane16_swap_b32 v225, v227
  buffer_store_dwordx4 v[224:227], v2, s[24:27], s77 offen offset:0 sc1
  v_or_b32 v14, 4, v3
  s_waitcnt vmcnt(1)
  s_mov_b64 exec, 1
  s_cmp_eq_u32 s61, 0
  s_cbranch_scc1 Lnl_22
  buffer_store_dword v14, off, s[24:27], s71
Lnle_23:
  s_mov_b64 exec, -1
  v_or_b32 v14, 5, v3
  s_waitcnt vmcnt(1)
  s_mov_b64 exec, 1
  s_cmp_eq_u32 s61, 0
  s_cbranch_scc1 Lnl_24
  buffer_store_dword v14, off, s[24:27], s71
Lnle_25:
  s_mov_b64 exec, -1
  s_cmp_lg_u32 s62, 0
  s_cbranch_scc1 Lnoep
  s_mov_b64 exec, 1
  buffer_store_dword v3, off, s[24:27], 0
  s_mov_b64 exec, -1
Lnoep:
  s_cmp_ge_u32 s57, 14
  s_cbranch_scc1 Lafin
  s_barrier
Lafin:
  s_endpgm
Lloader:
  s_cmp_eq_u32 s67, 7
  s_cbranch_scc1 Lx1_26
  s_lshr_b32 s64, s2, 3
  s_bitcmp1_b32 0x99999999, s64
  s_cselect_b32 s63, 16, s73
  s_bitcmp1_b32 s2, 0
  s_cselect_b32 s63, s63, s64
  s_cselect_b32 s65, 62, 33
  s_cselect_b32 s66, 25, 13
  v_lshlrev_b32 v8, 7, v1
  s_bitcmp1_b32 s63, 0
  s_cselect_b64 s[12:13], s[38:39], s[40:41]
  s_lshr_b32 s64, s63, 1
  s_mul_i32 s63, s63, 3
  s_add_u32 s63, s63, s52
  s_movk_i32 s14, 25088
  s_cmp_eq_u32 s52, 3
  s_cselect_b32 s63, s64, s63
  s_cselect_b32 s65, s66, s65
  s_cselect_b64 s[12:13], s[12:13], s[36:37]
  s_cselect_b32 s14, s14, 401408
  s_mul_i32 s63, s63, s65
  s_lshl_b32 s63, s63, 7
  s_bfm_b64 exec, s65, 0
  s_cmp_ge_u32 s70, 1
  s_cselect_b32 s63, 2146435072, s63
  buffer_load_dword v38, v8, s[12:15], s63 offen
  s_mov_b64 exec, -1
Lx1_26:
  s_lshr_b32 s54, s53, 2
  s_and_b32 s55, s53, 3
  s_mov_b32 s26, 33554432
  s_mov_b32 s27, 0x20000
  s_getreg_b32 s60, hwreg(HW_REG_XCC_ID, 0, 4)
  s_lshr_b32 s56, s53, 4
  s_and_b32 s57, s53, 15
  s_mov_b32 s59, 0x100000
  s_lshl2_add_u32 s62, s53, s52
  s_lshl_b32 s62, s62, 2
  v_and_b32 v4, 15, v1
  v_lshrrev_b32 v5, 4, v1
  v_min_u32 v6, 896, v2
  s_mul_i32 s65, s3, 928
  s_add_u32 s65, s65, 129536
  v_add_u32 v36, s65, v6
  v_add_u32 v37, 153600, v2
  s_and_b32 s65, s74, 31
  s_mul_i32 s65, s65, 912
  s_add_u32 s65, s65, 100352
  v_add_u32 v32, s65, v6
  s_and_b32 s65, s75, 31
  s_mul_i32 s65, s65, 912
  s_add_u32 s65, s65, 100352
  v_add_u32 v33, s65, v6
  s_and_b32 s65, s76, 31
  s_mul_i32 s65, s65, 912
  s_add_u32 s65, s65, 100352
  v_add_u32 v34, s65, v6
  s_and_b32 s65, s77, 31
  s_mul_i32 s65, s65, 912
  s_add_u32 s65, s65, 100352
  v_add_u32 v35, s65, v6
  s_cmp_eq_u32 s70, 0
  s_cbranch_scc0 Lnob0l
  s_barrier
Lnob0l:
  s_mov_b32 s30, 1835008
  s_mov_b32 s31, 0x20000
  v_and_b32 v6, 3, v4
  v_lshlrev_b32 v6, 3, v6
  v_lshrrev_b32 v7, 2, v4
  v_lshl_add_u32 v7, v5, 3, v7
  v_mul_u32_u24 v7, 56, v7
  s_lshr_b32 s66, s52, 1
  s_and_b32 s65, s52, 1
  s_mul_i32 s63, s66, 26624
  s_lshl_b32 s64, s65, 5
  s_add_u32 s63, s63, s64
  s_add_u32 s63, s63, 100352
  v_add3_u32 v39, v6, v7, s63
  v_lshrrev_b32 v6, 1, v1
  v_lshlrev_b32 v6, 4, v6
  v_and_b32 v7, 1, v1
  v_mul_u32_u24 v7, 896, v7
  s_mul_i32 s63, s66, 1792
  s_mul_i32 s64, s65, 448
  s_add_u32 s63, s63, s64
  s_add_u32 s63, s63, 153600
  v_add3_u32 v40, v6, v7, s63
  s_mul_i32 s80, s66, 0x3f800000
  s_mov_b32 s81, s80
  s_mul_i32 s82, s52, 896
  s_add_u32 s83, s82, 53248
  s_add_u32 s84, s82, 57344
  s_add_u32 s85, s82, 61440
  s_add_u32 s82, s82, 49152
  v_mov_b32 v6, 162816
  v_mov_b32 v7, 0
  v_mov_b32 v8, -16
  ds_write_b32 v6, v7 offset:4
  ds_write_b32 v6, v8 offset:516
  v_and_b32 v6, 7, v4
  v_mul_u32_u24 v7, 928, v6
  v_lshl_add_u32 v7, v5, 4, v7
  v_add_u32 v41, 129536, v7
  v_and_b32 v8, 1, v5
  v_lshlrev_b32 v8, 3, v8
  s_lshl_b32 s86, s54, 12
  s_add_u32 s86, s86, 262144
  s_cmp_ge_u32 s52, 2
  s_cbranch_scc1 Lvaddr_27
  v_lshl_add_u32 v8, v6, 4, v8
  v_lshrrev_b32 v7, 1, v5
  v_lshl_add_u32 v43, v7, 9, v8
  v_lshl_add_u32 v42, v7, 7, v8
  s_lshl_b32 s64, s52, 8
  s_add_u32 s64, s64, 161792
  v_add_u32 v42, s64, v42
  v_mov_b32 v44, 0x3f803f80
  v_mov_b32 v45, 0x00003f80
  s_lshl3_add_u32 s64, s52, s55
  s_lshl_b32 s64, s64, 7
  s_mov_b32 s78, 0
  s_mul_i32 s79, s65, 0xffff0000
  s_mov_b32 s88, 0x00ff00ff
  s_mov_b32 s89, 0x00ff00ff
  s_branch Laddr_e_28
Lvaddr_27:
  v_lshl_add_u32 v43, v4, 4, v8
  v_add_u32 v42, 162304, v43
  v_mov_b32 v44, 0
  v_mov_b32 v45, 0
  s_mov_b32 exec_lo, 0x10001000
  s_mov_b32 exec_hi, 0x10001000
  v_mov_b32 v44, 0x3f803f80
  v_mov_b32 v45, 0x3f803f80
  s_mov_b64 exec, -1
  s_lshl1_add_u32 s64, s55, s65
  s_lshl_b32 s64, s64, 8
  s_add_u32 s64, s64, 2048
  s_mul_i32 s78, s65, 0xf000f000
  s_mov_b32 s79, s78
  s_mov_b32 s88, -1
  s_mov_b32 s89, 0
Laddr_e_28:
  s_add_u32 s86, s86, s64
  s_mul_i32 s72, s56, 14
  s_add_u32 s72, s72, s57
  s_lshl1_add_u32 s63, s56, s57
  s_add_u32 s63, s63, 210
  s_lshl_b32 s36, s52, 8
  s_cmp_ge_u32 s57, 14
  s_cselect_b32 s72, s63, s72
  s_cselect_b32 s36, 0, s36
  s_add_u32 s36, s36, s72
  s_lshl_b32 s36, s36, 6
  s_add_u32 s36, s36, 196608
  s_and_b32 s68, s52, 1
  s_cselect_b32 s12, s48, s46
  s_cselect_b32 s13, s49, s47
  s_mul_i32 s37, s52, 4352
  s_add_u32 s37, s37, 136192
  v_lshrrev_b32 v6, 3, v1
  v_and_b32 v7, 2, v6
  v_and_b32 v8, 7, v1
  v_xor_b32 v8, v8, v7
  v_lshlrev_b32 v8, 4, v8
  v_mul_u32_u24 v6, 896, v6
  v_lshl_add_u32 v200, v6, 2, v8
  v_add_u32 v203, v6, v8
  v_lshl_add_u32 v204, v6, 1, v200
  v_and_b32 v6, 3, v4
  v_lshlrev_b32 v7, 3, v6
  v_lshrrev_b32 v8, 2, v4
  v_lshlrev_b32 v8, 7, v8
  v_mul_u32_u24 v9, 28672, v5
  v_add_u32 v8, v8, v9
  v_and_b32 v9, 8, v4
  v_lshlrev_b32 v9, 2, v9
  v_xad_u32 v201, v7, v9, v8
  v_xor_b32 v202, 32, v201
  v_mul_u32_u24 v205, 27584, v5
  v_sub_u32 v8, v8, v205
  v_add_u32 v8, s37, v8
  s_mov_b32 s18, 1605632
  s_movk_i32 s9, 7168
  s_movk_i32 s66, 32
  s_and_b32 s38, s55, 3
  s_lshl1_add_u32 s38, s38, 4
  s_cmp_ge_u32 s57, 14
  s_cbranch_scc1 Ljm2_31
  v_mov_b32 v204, v203
  s_cmp_ge_u32 s52, 2
  s_cbranch_scc1 Ljwd_29
  s_cmpk_ge_u32 s72, 168
  s_cbranch_scc1 Ljwo_30
  s_mov_b32 s16, s12
  s_mov_b32 s17, s13
  s_movk_i32 s9, 28672
  s_movk_i32 s11, 28672
  v_mov_b32 v203, v200
  v_mov_b32 v204, v200
  s_mul_i32 s63, s72, 5462
  s_lshr_b32 s63, s63, 16
  s_mul_i32 s64, s63, 12
  s_sub_u32 s64, s72, s64
  s_mul_i32 s65, s64, 21846
  s_lshr_b32 s65, s65, 16
  s_lshl2_add_u32 s64, s65, s64
  s_add_u32 s64, s64, 4
  s_mul_i32 s8, s63, 114688
  s_lshl1_add_u32 s63, s63, s68
  s_lshl_b32 s63, s63, 10
  s_mul_i32 s10, s64, 114688
  s_add_u32 s63, s63, 1048576
  s_cmp_eq_u32 0, 0
  s_branch Ljend_32
Ljm2_31:
  s_mov_b32 s16, s20
  s_mov_b32 s17, s21
  s_mov_b32 s18, 2408448
  s_mov_b32 s9, 43008
  s_movk_i32 s11, 0
  s_mov_b32 s38, 2
  v_mov_b32 v203, v204
  v_subrev_u32 v8, 21504, v8
  s_sub_u32 s64, s72, 210
  s_mul_i32 s8, s52, 172032
  s_lshl_b32 s10, s64, 7
  s_movk_i32 s63, 6400
  s_cmpk_lt_u32 s72, 252
  s_branch Ljend_32
Ljwd_29:
  s_mov_b32 s16, s50
  s_mov_b32 s17, s51
  s_movk_i32 s11, 1024
  v_lshlrev_b32 v7, 4, v6
  s_mul_i32 s63, s72, 9363
  s_lshr_b32 s63, s63, 16
  s_mul_i32 s64, s63, 7
  s_sub_u32 s64, s72, s64
  s_bitcmp1_b32 0x204081, s63
  s_cselect_b32 s38, 1, s38
  s_lshl1_add_u32 s63, s63, s68
  s_mul_i32 s8, s63, 28672
  s_lshl_b32 s63, s63, 12
  s_mul_i32 s10, s64, 229376
  s_add_u32 s63, s63, 4259840
  s_movk_i32 s66, 8
  s_cmpk_lt_u32 s72, 196
  s_branch Ljend_32
Ljwo_30:
  s_mov_b32 s16, s42
  s_mov_b32 s17, s43
  s_mov_b32 s18, 401408
  s_movk_i32 s11, 16384
  s_mov_b32 s38, 1
  v_and_b32 v7, 1, v4
  v_lshlrev_b32 v7, 4, v7
  v_and_b32 v6, 2, v4
  v_lshl_add_u32 v7, v6, 2, v7
  s_mov_b32 exec_lo, 0
  v_mov_b32 v204, 2146435072
  s_mov_b32 exec_lo, -1
  s_sub_u32 s65, s72, 168
  s_lshl1_add_u32 s65, s65, s68
  s_mul_i32 s63, s65, 9363
  s_lshr_b32 s63, s63, 16
  s_mul_i32 s64, s63, 7
  s_sub_u32 s64, s65, s64
  s_mul_i32 s8, s63, 25088
  s_lshl_b32 s63, s63, 10
  s_lshl_b32 s10, s64, 16
  s_add_u32 s63, s63, 524288
  s_cmp_eq_u32 0, 0
Ljend_32:
  s_cselect_b32 s8, s8, 2146435072
  s_cselect_b32 s10, s10, 2129657856
  s_lshl_b32 s64, s64, 7
  s_add_u32 s8, s8, s64
  s_add_u32 s10, s10, s63
  v_xad_u32 v205, v7, v9, v8
  v_xor_b32 v206, s66, v205
  s_setprio 3
  s_cmp_eq_u32 s67, 7
  s_cbranch_scc0 Lnomod2_33
  v_add_u32 v8, 157696, v2
  s_mul_i32 s63, s71, 224
  s_add_u32 s63, s63, 157696
  v_lshl_add_u32 v6, v5, 3, s63
  v_lshrrev_b32 v7, 2, v1
  v_lshlrev_b32 v7, 7, v7
  v_and_b32 v9, 3, v1
  v_lshl_add_u32 v7, v9, 3, v7
  v_add_u32 v7, 86016, v7
  v_lshlrev_b32 v9, 6, v4
  v_lshl_add_u32 v9, v5, 4, v9
  s_mul_i32 s64, s71, 4032
  s_lshl_b32 s63, s69, 6
  s_add_u32 s63, s63, s64
  s_add_u32 s63, s63, 49152
  s_waitcnt vmcnt(18)
  v_lshlrev_b32 v152, 16, v12
  v_and_b32 v153, 0xffff0000, v12
  v_lshlrev_b32 v154, 16, v13
  v_and_b32 v155, 0xffff0000, v13
  v_lshlrev_b32 v156, 16, v14
  v_and_b32 v157, 0xffff0000, v14
  v_lshlrev_b32 v158, 16, v15
  v_and_b32 v159, 0xffff0000, v15
  v_mul_f32 v160, 0xbfb8aa3b, v152
  v_mul_f32 v161, 0xbfb8aa3b, v153
  v_mul_f32 v162, 0xbfb8aa3b, v154
  v_mul_f32 v163, 0xbfb8aa3b, v155
  v_mul_f32 v164, 0xbfb8aa3b, v156
  v_mul_f32 v165, 0xbfb8aa3b, v157
  v_mul_f32 v166, 0xbfb8aa3b, v158
  v_mul_f32 v167, 0xbfb8aa3b, v159
  v_exp_f32 v160, v160
  v_exp_f32 v161, v161
  v_exp_f32 v162, v162
  v_exp_f32 v163, v163
  v_exp_f32 v164, v164
  v_exp_f32 v165, v165
  v_exp_f32 v166, v166
  v_exp_f32 v167, v167
  v_add_f32 v160, 1.0, v160
  v_add_f32 v161, 1.0, v161
  v_add_f32 v162, 1.0, v162
  v_add_f32 v163, 1.0, v163
  v_add_f32 v164, 1.0, v164
  v_add_f32 v165, 1.0, v165
  v_add_f32 v166, 1.0, v166
  v_add_f32 v167, 1.0, v167
  v_rcp_f32 v160, v160
  v_rcp_f32 v161, v161
  v_rcp_f32 v162, v162
  v_rcp_f32 v163, v163
  v_rcp_f32 v164, v164
  v_rcp_f32 v165, v165
  v_rcp_f32 v166, v166
  v_rcp_f32 v167, v167
  v_mul_f32 v152, v152, v160
  v_mul_f32 v153, v153, v161
  v_mul_f32 v154, v154, v162
  v_mul_f32 v155, v155, v163
  v_mul_f32 v156, v156, v164
  v_mul_f32 v157, v157, v165
  v_mul_f32 v158, v158, v166
  v_mul_f32 v159, v159, v167
  v_cvt_pk_bf16_f32 v12, v152, v153
  v_cvt_pk_bf16_f32 v13, v154, v155
  v_cvt_pk_bf16_f32 v14, v156, v157
  v_cvt_pk_bf16_f32 v15, v158, v159
  ds_write_b128 v8, v[12:15]
  ds_read_b64 v[46:47], v6 offset:0
  ds_read_b64 v[48:49], v6 offset:32
  ds_read_b64 v[50:51], v6 offset:64
  ds_read_b64 v[52:53], v6 offset:96
  ds_read_b64 v[54:55], v6 offset:128
  ds_read_b64 v[56:57], v6 offset:160
  ds_read_b64 v[58:59], v6 offset:192
  s_waitcnt lgkmcnt(0)
  s_and_b32 s64, s58, 0xfffffff0
  s_add_u32 s64, s64, 0x9e3779b0
  v_mov_b32 v13, s64
  v_mov_b32 v15, s64
  s_waitcnt vmcnt(16)
  ds_read_b64_tr_b16 v[112:113], v7 offset:0
  ds_read_b64_tr_b16 v[114:115], v7 offset:32
  ds_read_b64_tr_b16 v[116:117], v7 offset:64
  ds_read_b64_tr_b16 v[118:119], v7 offset:96
  s_waitcnt vmcnt(14)
  ds_read_b64_tr_b16 v[120:121], v7 offset:2048
  ds_read_b64_tr_b16 v[122:123], v7 offset:2080
  ds_read_b64_tr_b16 v[124:125], v7 offset:2112
  ds_read_b64_tr_b16 v[126:127], v7 offset:2144
  s_waitcnt vmcnt(12)
  ds_read_b64_tr_b16 v[128:129], v7 offset:4096
  ds_read_b64_tr_b16 v[130:131], v7 offset:4128
  ds_read_b64_tr_b16 v[132:133], v7 offset:4160
  ds_read_b64_tr_b16 v[134:135], v7 offset:4192
  s_waitcnt lgkmcnt(11)
  v_mfma_f32_16x16x16_bf16 v[136:139], v[112:113], v[46:47], 0
  s_waitcnt lgkmcnt(10)
  v_mfma_f32_16x16x16_bf16 v[140:143], v[114:115], v[46:47], 0
  s_waitcnt lgkmcnt(9)
  v_mfma_f32_16x16x16_bf16 v[144:147], v[116:117], v[46:47], 0
  s_waitcnt lgkmcnt(8)
  v_mfma_f32_16x16x16_bf16 v[148:151], v[118:119], v[46:47], 0
  s_waitcnt vmcnt(10)
  ds_read_b64_tr_b16 v[112:113], v7 offset:6144
  ds_read_b64_tr_b16 v[114:115], v7 offset:6176
  ds_read_b64_tr_b16 v[116:117], v7 offset:6208
  ds_read_b64_tr_b16 v[118:119], v7 offset:6240
  s_waitcnt lgkmcnt(11)
  v_mfma_f32_16x16x16_bf16 v[136:139], v[120:121], v[48:49], v[136:139]
  s_waitcnt lgkmcnt(10)
  v_mfma_f32_16x16x16_bf16 v[140:143], v[122:123], v[48:49], v[140:143]
  s_waitcnt lgkmcnt(9)
  v_mfma_f32_16x16x16_bf16 v[144:147], v[124:125], v[48:49], v[144:147]
  s_waitcnt lgkmcnt(8)
  v_mfma_f32_16x16x16_bf16 v[148:151], v[126:127], v[48:49], v[148:151]
  s_waitcnt vmcnt(8)
  ds_read_b64_tr_b16 v[120:121], v7 offset:8192
  ds_read_b64_tr_b16 v[122:123], v7 offset:8224
  ds_read_b64_tr_b16 v[124:125], v7 offset:8256
  ds_read_b64_tr_b16 v[126:127], v7 offset:8288
  s_waitcnt lgkmcnt(11)
  v_mfma_f32_16x16x16_bf16 v[136:139], v[128:129], v[50:51], v[136:139]
  s_waitcnt lgkmcnt(10)
  v_mfma_f32_16x16x16_bf16 v[140:143], v[130:131], v[50:51], v[140:143]
  s_waitcnt lgkmcnt(9)
  v_mfma_f32_16x16x16_bf16 v[144:147], v[132:133], v[50:51], v[144:147]
  s_waitcnt lgkmcnt(8)
  v_mfma_f32_16x16x16_bf16 v[148:151], v[134:135], v[50:51], v[148:151]
  s_waitcnt vmcnt(6)
  ds_read_b64_tr_b16 v[128:129], v7 offset:10240
  ds_read_b64_tr_b16 v[130:131], v7 offset:10272
  ds_read_b64_tr_b16 v[132:133], v7 offset:10304
  ds_read_b64_tr_b16 v[134:135], v7 offset:10336
  s_waitcnt lgkmcnt(11)
  v_mfma_f32_16x16x16_bf16 v[136:139], v[112:113], v[52:53], v[136:139]
  s_waitcnt lgkmcnt(10)
  v_mfma_f32_16x16x16_bf16 v[140:143], v[114:115], v[52:53], v[140:143]
  s_waitcnt lgkmcnt(9)
  v_mfma_f32_16x16x16_bf16 v[144:147], v[116:117], v[52:53], v[144:147]
  s_waitcnt lgkmcnt(8)
  v_mfma_f32_16x16x16_bf16 v[148:151], v[118:119], v[52:53], v[148:151]
  s_waitcnt vmcnt(4)
  ds_read_b64_tr_b16 v[112:113], v7 offset:12288
  ds_read_b64_tr_b16 v[114:115], v7 offset:12320
  ds_read_b64_tr_b16 v[116:117], v7 offset:12352
  ds_read_b64_tr_b16 v[118:119], v7 offset:12384
  s_waitcnt lgkmcnt(11)
  v_mfma_f32_16x16x16_bf16 v[136:139], v[120:121], v[54:55], v[136:139]
  s_waitcnt lgkmcnt(10)
  v_mfma_f32_16x16x16_bf16 v[140:143], v[122:123], v[54:55], v[140:143]
  s_waitcnt lgkmcnt(9)
  v_mfma_f32_16x16x16_bf16 v[144:147], v[124:125], v[54:55], v[144:147]
  s_waitcnt lgkmcnt(8)
  v_mfma_f32_16x16x16_bf16 v[148:151], v[126:127], v[54:55], v[148:151]
  s_waitcnt lgkmcnt(7)
  v_mfma_f32_16x16x16_bf16 v[136:139], v[128:129], v[56:57], v[136:139]
  s_waitcnt lgkmcnt(6)
  v_mfma_f32_16x16x16_bf16 v[140:143], v[130:131], v[56:57], v[140:143]
  s_waitcnt lgkmcnt(5)
  v_mfma_f32_16x16x16_bf16 v[144:147], v[132:133], v[56:57], v[144:147]
  s_waitcnt lgkmcnt(4)
  v_mfma_f32_16x16x16_bf16 v[148:151], v[134:135], v[56:57], v[148:151]
  s_waitcnt lgkmcnt(3)
  v_mfma_f32_16x16x16_bf16 v[136:139], v[112:113], v[58:59], v[136:139]
  s_waitcnt lgkmcnt(2)
  v_mfma_f32_16x16x16_bf16 v[140:143], v[114:115], v[58:59], v[140:143]
  s_waitcnt lgkmcnt(1)
  v_mfma_f32_16x16x16_bf16 v[144:147], v[116:117], v[58:59], v[144:147]
  s_waitcnt lgkmcnt(0)
  v_mfma_f32_16x16x16_bf16 v[148:151], v[118:119], v[58:59], v[148:151]
  s_nop 1
  v_cvt_pk_bf16_f32 v12, v136, v137
  v_cvt_pk_bf16_f32 v14, v138, v139
  s_mov_b32 exec_lo, 131074
  s_mov_b32 exec_hi, 131074
  v_cvt_pk_bf16_f32 v12, v140, v141
  v_cvt_pk_bf16_f32 v14, v142, v143
  s_mov_b32 exec_lo, 262148
  s_mov_b32 exec_hi, 262148
  v_cvt_pk_bf16_f32 v12, v144, v145
  v_cvt_pk_bf16_f32 v14, v146, v147
  s_mov_b32 exec_lo, 524296
  s_mov_b32 exec_hi, 524296
  v_cvt_pk_bf16_f32 v12, v148, v149
  v_cvt_pk_bf16_f32 v14, v150, v151
  s_mov_b32 exec_lo, 0x000f000f
  s_mov_b32 exec_hi, 0x000f000f
  buffer_store_dwordx4 v[12:15], v9, s[24:27], s63 offen sc1
  s_mov_b64 exec, -1
Lnomod2_33:
  s_waitcnt vmcnt(1)
  v_mov_b32 v10, 0x3f803f80
  v_dot2_f32_bf16 v46, v16, v10, 0
  v_dot2_f32_bf16 v50, v16, v16, 0
  v_dot2_f32_bf16 v47, v20, v10, 0
  v_dot2_f32_bf16 v51, v20, v20, 0
  v_dot2_f32_bf16 v48, v24, v10, 0
  v_dot2_f32_bf16 v52, v24, v24, 0
  v_dot2_f32_bf16 v49, v28, v10, 0
  v_dot2_f32_bf16 v53, v28, v28, 0
  v_dot2_f32_bf16 v46, v17, v10, v46
  v_dot2_f32_bf16 v50, v17, v17, v50
  v_dot2_f32_bf16 v47, v21, v10, v47
  v_dot2_f32_bf16 v51, v21, v21, v51
  v_dot2_f32_bf16 v48, v25, v10, v48
  v_dot2_f32_bf16 v52, v25, v25, v52
  v_dot2_f32_bf16 v49, v29, v10, v49
  v_dot2_f32_bf16 v53, v29, v29, v53
  v_dot2_f32_bf16 v46, v18, v10, v46
  v_dot2_f32_bf16 v50, v18, v18, v50
  v_dot2_f32_bf16 v47, v22, v10, v47
  v_dot2_f32_bf16 v51, v22, v22, v51
  v_dot2_f32_bf16 v48, v26, v10, v48
  v_dot2_f32_bf16 v52, v26, v26, v52
  v_dot2_f32_bf16 v49, v30, v10, v49
  v_dot2_f32_bf16 v53, v30, v30, v53
  v_dot2_f32_bf16 v46, v19, v10, v46
  v_dot2_f32_bf16 v50, v19, v19, v50
  v_dot2_f32_bf16 v47, v23, v10, v47
  v_dot2_f32_bf16 v51, v23, v23, v51
  v_dot2_f32_bf16 v48, v27, v10, v48
  v_dot2_f32_bf16 v52, v27, v27, v52
  v_dot2_f32_bf16 v49, v31, v10, v49
  v_dot2_f32_bf16 v53, v31, v31, v53
  v_lshlrev_b32 v64, 16, v16
  v_and_b32 v65, 0xffff0000, v16
  v_lshlrev_b32 v66, 16, v17
  v_and_b32 v67, 0xffff0000, v17
  v_permlane32_swap_b32 v46, v47
  v_permlane32_swap_b32 v48, v49
  v_permlane32_swap_b32 v50, v51
  v_permlane32_swap_b32 v52, v53
  v_add_f32 v46, v46, v47
  v_add_f32 v48, v48, v49
  v_add_f32 v50, v50, v51
  v_add_f32 v52, v52, v53
  v_lshlrev_b32 v68, 16, v18
  v_and_b32 v69, 0xffff0000, v18
  v_permlane16_swap_b32 v46, v48
  v_permlane16_swap_b32 v50, v52
  v_add_f32 v46, v46, v48
  v_add_f32 v50, v50, v52
  v_lshlrev_b32 v70, 16, v19
  v_and_b32 v71, 0xffff0000, v19
  v_add_f32_dpp v46, v46, v46 row_ror:8 row_mask:0xf bank_mask:0xf
  v_add_f32_dpp v50, v50, v50 row_ror:8 row_mask:0xf bank_mask:0xf
  v_lshlrev_b32 v72, 16, v20
  v_and_b32 v73, 0xffff0000, v20
  v_add_f32_dpp v46, v46, v46 row_ror:4 row_mask:0xf bank_mask:0xf
  v_add_f32_dpp v50, v50, v50 row_ror:4 row_mask:0xf bank_mask:0xf
  v_lshlrev_b32 v74, 16, v21
  v_and_b32 v75, 0xffff0000, v21
  v_add_f32_dpp v46, v46, v46 row_ror:2 row_mask:0xf bank_mask:0xf
  v_add_f32_dpp v50, v50, v50 row_ror:2 row_mask:0xf bank_mask:0xf
  v_lshlrev_b32 v76, 16, v22
  v_and_b32 v77, 0xffff0000, v22
  v_add_f32_dpp v46, v46, v46 row_ror:1 row_mask:0xf bank_mask:0xf
  v_add_f32_dpp v50, v50, v50 row_ror:1 row_mask:0xf bank_mask:0xf
  v_mul_f32 v46, 0xbb124925, v46
  v_mul_f32 v50, 0x3b124925, v50
  v_fma_f32 v50, -v46, v46, v50
  v_max_f32 v50, 0, v50
  v_add_f32 v50, 0x3727c5ac, v50
  v_rsq_f32 v50, v50
  v_lshlrev_b32 v78, 16, v23
  v_and_b32 v79, 0xffff0000, v23
  v_mul_f32 v46, v46, v50
  v_lshlrev_b32 v80, 16, v24
  v_and_b32 v81, 0xffff0000, v24
  v_readlane_b32 s90, v50, 0
  v_readlane_b32 s91, v46, 0
  v_readlane_b32 s92, v50, 32
  v_readlane_b32 s93, v46, 32
  v_readlane_b32 s94, v50, 16
  v_readlane_b32 s95, v46, 16
  v_readlane_b32 s96, v50, 48
  v_readlane_b32 s97, v46, 48
  v_lshlrev_b32 v82, 16, v25
  v_and_b32 v83, 0xffff0000, v25
  v_lshlrev_b32 v84, 16, v26
  v_and_b32 v85, 0xffff0000, v26
  v_lshlrev_b32 v86, 16, v27
  v_and_b32 v87, 0xffff0000, v27
  v_lshlrev_b32 v88, 16, v28
  v_and_b32 v89, 0xffff0000, v28
  v_lshlrev_b32 v90, 16, v29
  v_and_b32 v91, 0xffff0000, v29
  v_lshlrev_b32 v92, 16, v30
  v_and_b32 v93, 0xffff0000, v30
  v_lshlrev_b32 v94, 16, v31
  v_and_b32 v95, 0xffff0000, v31
  v_pk_fma_f32 v[64:65], v[64:65], s[90:91], s[90:91] op_sel:[0,0,1] op_sel_hi:[1,0,1]
  v_pk_fma_f32 v[66:67], v[66:67], s[90:91], s[90:91] op_sel:[0,0,1] op_sel_hi:[1,0,1]
  v_pk_fma_f32 v[68:69], v[68:69], s[90:91], s[90:91] op_sel:[0,0,1] op_sel_hi:[1,0,1]
  v_pk_fma_f32 v[70:71], v[70:71], s[90:91], s[90:91] op_sel:[0,0,1] op_sel_hi:[1,0,1]
  v_pk_fma_f32 v[72:73], v[72:73], s[92:93], s[92:93] op_sel:[0,0,1] op_sel_hi:[1,0,1]
  v_pk_fma_f32 v[74:75], v[74:75], s[92:93], s[92:93] op_sel:[0,0,1] op_sel_hi:[1,0,1]
  v_pk_fma_f32 v[76:77], v[76:77], s[92:93], s[92:93] op_sel:[0,0,1] op_sel_hi:[1,0,1]
  v_pk_fma_f32 v[78:79], v[78:79], s[92:93], s[92:93] op_sel:[0,0,1] op_sel_hi:[1,0,1]
  v_pk_fma_f32 v[80:81], v[80:81], s[94:95], s[94:95] op_sel:[0,0,1] op_sel_hi:[1,0,1]
  v_pk_fma_f32 v[82:83], v[82:83], s[94:95], s[94:95] op_sel:[0,0,1] op_sel_hi:[1,0,1]
  v_pk_fma_f32 v[84:85], v[84:85], s[94:95], s[94:95] op_sel:[0,0,1] op_sel_hi:[1,0,1]
  v_pk_fma_f32 v[86:87], v[86:87], s[94:95], s[94:95] op_sel:[0,0,1] op_sel_hi:[1,0,1]
  v_pk_fma_f32 v[88:89], v[88:89], s[96:97], s[96:97] op_sel:[0,0,1] op_sel_hi:[1,0,1]
  v_pk_fma_f32 v[90:91], v[90:91], s[96:97], s[96:97] op_sel:[0,0,1] op_sel_hi:[1,0,1]
  v_pk_fma_f32 v[92:93], v[92:93], s[96:97], s[96:97] op_sel:[0,0,1] op_sel_hi:[1,0,1]
  v_pk_fma_f32 v[94:95], v[94:95], s[96:97], s[96:97] op_sel:[0,0,1] op_sel_hi:[1,0,1]
  s_waitcnt lgkmcnt(0)
  s_and_b32 s58, s58, 0xfffffff0
  s_add_u32 s58, s58, 0x9e3779b0
  v_mov_b32 v3, s58
  s_barrier
  s_mov_b32 exec_hi, 0x00ffffff
  buffer_load_dwordx4 v[224:227], v2, s[24:27], s82 offen sc1
  buffer_load_dwordx4 v[228:231], v2, s[24:27], s83 offen sc1
  buffer_load_dwordx4 v[232:235], v2, s[24:27], s84 offen sc1
  buffer_load_dwordx4 v[236:239], v2, s[24:27], s85 offen sc1
  s_mov_b32 exec_hi, -1
  s_barrier
  ds_read_b64_tr_b16 v[112:113], v39 offset:0
  ds_read_b64_tr_b16 v[114:115], v39 offset:224
  ds_read_b64_tr_b16 v[116:117], v39 offset:1792
  ds_read_b64_tr_b16 v[118:119], v39 offset:2016
  ds_read_b64_tr_b16 v[120:121], v39 offset:3584
  ds_read_b64_tr_b16 v[122:123], v39 offset:3808
  ds_read_b64_tr_b16 v[124:125], v39 offset:5376
  ds_read_b64_tr_b16 v[126:127], v39 offset:5600
  ds_read_b64_tr_b16 v[128:129], v39 offset:7168
  ds_read_b64_tr_b16 v[130:131], v39 offset:7392
  ds_read_b64_tr_b16 v[132:133], v39 offset:8960
  ds_read_b64_tr_b16 v[134:135], v39 offset:9184
  ds_read_b64_tr_b16 v[136:137], v39 offset:10752
  ds_read_b64_tr_b16 v[138:139], v39 offset:10976
  ds_read_b64_tr_b16 v[140:141], v39 offset:12544
  ds_read_b64_tr_b16 v[142:143], v39 offset:12768
  ds_read_b64_tr_b16 v[144:145], v39 offset:14336
  ds_read_b64_tr_b16 v[146:147], v39 offset:14560
  ds_read_b64_tr_b16 v[148:149], v39 offset:16128
  ds_read_b64_tr_b16 v[150:151], v39 offset:16352
  ds_read_b64_tr_b16 v[152:153], v39 offset:17920
  ds_read_b64_tr_b16 v[154:155], v39 offset:18144
  ds_read_b64_tr_b16 v[156:157], v39 offset:19712
  ds_read_b64_tr_b16 v[158:159], v39 offset:19936
  ds_read_b64_tr_b16 v[160:161], v39 offset:21504
  ds_read_b64_tr_b16 v[162:163], v39 offset:21728
  ds_read_b64_tr_b16 v[164:165], v39 offset:23296
  ds_read_b64_tr_b16 v[166:167], v39 offset:23520
  s_mov_b32 exec_hi, 0x00ffffff
  s_waitcnt vmcnt(3)
  v_xor_b32 v6, v3, v225
  v_bitop3_b32 v6, v6, v227, v3 bitop3:0xf6
  s_waitcnt vmcnt(2)
  v_bitop3_b32 v6, v6, v229, v3 bitop3:0xf6
  v_bitop3_b32 v6, v6, v231, v3 bitop3:0xf6
  s_waitcnt vmcnt(1)
  v_bitop3_b32 v6, v6, v233, v3 bitop3:0xf6
  v_bitop3_b32 v6, v6, v235, v3 bitop3:0xf6
  s_waitcnt vmcnt(0)
  v_bitop3_b32 v6, v6, v237, v3 bitop3:0xf6
  v_bitop3_b32 v6, v6, v239, v3 bitop3:0xf6
  v_cmp_ne_u32 vcc, 0, v6
  s_cbranch_vccz Lmok_34
Lpoll_35:
  buffer_load_dwordx4 v[224:227], v2, s[24:27], s82 offen sc1
  buffer_load_dwordx4 v[228:231], v2, s[24:27], s83 offen sc1
  buffer_load_dwordx4 v[232:235], v2, s[24:27], s84 offen sc1
  buffer_load_dwordx4 v[236:239], v2, s[24:27], s85 offen sc1
  s_sub_u32 s59, s59, 1
  s_cmp_lt_i32 s59, 0
  s_cbranch_scc1 Lpdone_36
  s_waitcnt vmcnt(3)
  v_xor_b32 v6, v3, v225
  v_bitop3_b32 v6, v6, v227, v3 bitop3:0xf6
  s_waitcnt vmcnt(2)
  v_bitop3_b32 v6, v6, v229, v3 bitop3:0xf6
  v_bitop3_b32 v6, v6, v231, v3 bitop3:0xf6
  s_waitcnt vmcnt(1)
  v_bitop3_b32 v6, v6, v233, v3 bitop3:0xf6
  v_bitop3_b32 v6, v6, v235, v3 bitop3:0xf6
  s_waitcnt vmcnt(0)
  v_bitop3_b32 v6, v6, v237, v3 bitop3:0xf6
  v_bitop3_b32 v6, v6, v239, v3 bitop3:0xf6
  v_cmp_ne_u32 vcc, 0, v6
  s_cbranch_vccnz Lpoll_35
Lpdone_36:
Lmok_34:
  s_waitcnt vmcnt(3)
  v_lshlrev_b32 v240, 16, v224
  v_and_b32 v241, 0xffff0000, v224
  v_lshlrev_b32 v242, 16, v226
  v_and_b32 v243, 0xffff0000, v226
  s_waitcnt vmcnt(2)
  v_lshlrev_b32 v244, 16, v228
  v_and_b32 v245, 0xffff0000, v228
  v_lshlrev_b32 v246, 16, v230
  v_and_b32 v247, 0xffff0000, v230
  s_waitcnt vmcnt(1)
  v_lshlrev_b32 v248, 16, v232
  v_and_b32 v249, 0xffff0000, v232
  v_lshlrev_b32 v250, 16, v234
  v_and_b32 v251, 0xffff0000, v234
  s_waitcnt vmcnt(0)
  v_lshlrev_b32 v252, 16, v236
  v_and_b32 v253, 0xffff0000, v236
  v_lshlrev_b32 v254, 16, v238
  v_and_b32 v255, 0xffff0000, v238
  v_pk_add_f32 v[240:241], v[240:241], v[244:245]
  v_pk_add_f32 v[248:249], v[248:249], v[252:253]
  v_pk_add_f32 v[242:243], v[242:243], v[246:247]
  v_pk_add_f32 v[250:251], v[250:251], v[254:255]
  v_pk_add_f32 v[240:241], v[240:241], v[248:249]
  v_pk_add_f32 v[242:243], v[242:243], v[250:251]
  v_pk_add_f32 v[240:241], v[240:241], s[80:81]
  v_pk_add_f32 v[242:243], v[242:243], s[80:81]
  ds_write_b128 v40, v[240:243]
  s_mov_b32 exec_hi, -1
  s_waitcnt lgkmcnt(0)
  s_barrier
  ds_read_b128 v[104:107], v37 offset:1792
  ds_read_b128 v[96:99], v37 offset:0
  ds_read_b128 v[108:111], v37 offset:2688
  ds_read_b128 v[100:103], v37 offset:896
  s_waitcnt lgkmcnt(2)
  v_pk_fma_f32 v[64:65], v[64:65], v[104:105], v[96:97]
  v_pk_fma_f32 v[66:67], v[66:67], v[106:107], v[98:99]
  v_cvt_pk_bf16_f32 v16, v64, v65
  s_waitcnt lgkmcnt(0)
  v_pk_fma_f32 v[68:69], v[68:69], v[108:109], v[100:101]
  v_cvt_pk_bf16_f32 v17, v66, v67
  v_pk_fma_f32 v[70:71], v[70:71], v[110:111], v[102:103]
  v_cvt_pk_bf16_f32 v18, v68, v69
  v_cvt_pk_bf16_f32 v19, v70, v71
  ds_write_b128 v36, v[16:19]
  s_cmp_ge_u32 s52, 2
  s_waitcnt lgkmcnt(0)
  s_barrier
  ds_read_b128 v[168:171], v41 offset:0
  ds_read_b128 v[172:175], v41 offset:64
  ds_read_b128 v[176:179], v41 offset:128
  ds_read_b128 v[180:183], v41 offset:192
  ds_read_b128 v[184:187], v41 offset:256
  ds_read_b128 v[188:191], v41 offset:320
  ds_read_b128 v[192:195], v41 offset:384
  ds_read_b128 v[196:199], v41 offset:448
  ds_read_b128 v[224:227], v41 offset:512
  ds_read_b128 v[228:231], v41 offset:576
  ds_read_b128 v[232:235], v41 offset:640
  ds_read_b128 v[236:239], v41 offset:704
  ds_read_b128 v[240:243], v41 offset:768
  ds_read_b128 v[244:247], v41 offset:832
  s_cbranch_scc1 Lvmm_37
  v_pk_fma_f32 v[72:73], v[72:73], v[104:105], v[96:97]
  v_pk_fma_f32 v[74:75], v[74:75], v[106:107], v[98:99]
  v_pk_fma_f32 v[76:77], v[76:77], v[108:109], v[100:101]
  v_pk_fma_f32 v[78:79], v[78:79], v[110:111], v[102:103]
  s_waitcnt lgkmcnt(13)
  v_mfma_f32_16x16x32_bf16 v[46:49], v[112:115], v[168:171], 0
  v_cvt_pk_bf16_f32 v20, v72, v73
  s_waitcnt lgkmcnt(12)
  v_mfma_f32_16x16x32_bf16 v[46:49], v[116:119], v[172:175], v[46:49]
  v_cvt_pk_bf16_f32 v21, v74, v75
  s_waitcnt lgkmcnt(11)
  v_mfma_f32_16x16x32_bf16 v[46:49], v[120:123], v[176:179], v[46:49]
  v_cvt_pk_bf16_f32 v22, v76, v77
  s_waitcnt lgkmcnt(10)
  v_mfma_f32_16x16x32_bf16 v[46:49], v[124:127], v[180:183], v[46:49]
  v_cvt_pk_bf16_f32 v23, v78, v79
  s_waitcnt lgkmcnt(9)
  v_mfma_f32_16x16x32_bf16 v[46:49], v[128:131], v[184:187], v[46:49]
  v_pk_fma_f32 v[80:81], v[80:81], v[104:105], v[96:97]
  s_waitcnt lgkmcnt(8)
  v_mfma_f32_16x16x32_bf16 v[46:49], v[132:135], v[188:191], v[46:49]
  v_pk_fma_f32 v[82:83], v[82:83], v[106:107], v[98:99]
  s_waitcnt lgkmcnt(7)
  v_mfma_f32_16x16x32_bf16 v[46:49], v[136:139], v[192:195], v[46:49]
  v_pk_fma_f32 v[84:85], v[84:85], v[108:109], v[100:101]
  s_waitcnt lgkmcnt(6)
  v_mfma_f32_16x16x32_bf16 v[46:49], v[140:143], v[196:199], v[46:49]
  v_pk_fma_f32 v[86:87], v[86:87], v[110:111], v[102:103]
  s_waitcnt lgkmcnt(5)
  v_mfma_f32_16x16x32_bf16 v[46:49], v[144:147], v[224:227], v[46:49]
  v_cvt_pk_bf16_f32 v24, v80, v81
  s_waitcnt lgkmcnt(4)
  v_mfma_f32_16x16x32_bf16 v[46:49], v[148:151], v[228:231], v[46:49]
  v_cvt_pk_bf16_f32 v25, v82, v83
  s_waitcnt lgkmcnt(3)
  v_mfma_f32_16x16x32_bf16 v[46:49], v[152:155], v[232:235], v[46:49]
  v_cvt_pk_bf16_f32 v26, v84, v85
  s_waitcnt lgkmcnt(2)
  v_mfma_f32_16x16x32_bf16 v[46:49], v[156:159], v[236:239], v[46:49]
  v_cvt_pk_bf16_f32 v27, v86, v87
  s_waitcnt lgkmcnt(1)
  v_mfma_f32_16x16x32_bf16 v[46:49], v[160:163], v[240:243], v[46:49]
  v_pk_fma_f32 v[88:89], v[88:89], v[104:105], v[96:97]
  s_waitcnt lgkmcnt(0)
  v_mfma_f32_16x16x32_bf16 v[46:49], v[164:167], v[244:247], v[46:49]
  v_pk_fma_f32 v[90:91], v[90:91], v[106:107], v[98:99]
  s_branch Lmm_e_38
Lvmm_37:
  v_pk_fma_f32 v[72:73], v[72:73], v[104:105], v[96:97]
  v_pk_fma_f32 v[74:75], v[74:75], v[106:107], v[98:99]
  v_pk_fma_f32 v[76:77], v[76:77], v[108:109], v[100:101]
  v_pk_fma_f32 v[78:79], v[78:79], v[110:111], v[102:103]
  s_waitcnt lgkmcnt(13)
  v_mfma_f32_16x16x32_bf16 v[46:49], v[168:171], v[112:115], 0
  v_cvt_pk_bf16_f32 v20, v72, v73
  s_waitcnt lgkmcnt(12)
  v_mfma_f32_16x16x32_bf16 v[46:49], v[172:175], v[116:119], v[46:49]
  v_cvt_pk_bf16_f32 v21, v74, v75
  s_waitcnt lgkmcnt(11)
  v_mfma_f32_16x16x32_bf16 v[46:49], v[176:179], v[120:123], v[46:49]
  v_cvt_pk_bf16_f32 v22, v76, v77
  s_waitcnt lgkmcnt(10)
  v_mfma_f32_16x16x32_bf16 v[46:49], v[180:183], v[124:127], v[46:49]
  v_cvt_pk_bf16_f32 v23, v78, v79
  s_waitcnt lgkmcnt(9)
  v_mfma_f32_16x16x32_bf16 v[46:49], v[184:187], v[128:131], v[46:49]
  v_pk_fma_f32 v[80:81], v[80:81], v[104:105], v[96:97]
  s_waitcnt lgkmcnt(8)
  v_mfma_f32_16x16x32_bf16 v[46:49], v[188:191], v[132:135], v[46:49]
  v_pk_fma_f32 v[82:83], v[82:83], v[106:107], v[98:99]
  s_waitcnt lgkmcnt(7)
  v_mfma_f32_16x16x32_bf16 v[46:49], v[192:195], v[136:139], v[46:49]
  v_pk_fma_f32 v[84:85], v[84:85], v[108:109], v[100:101]
  s_waitcnt lgkmcnt(6)
  v_mfma_f32_16x16x32_bf16 v[46:49], v[196:199], v[140:143], v[46:49]
  v_pk_fma_f32 v[86:87], v[86:87], v[110:111], v[102:103]
  s_waitcnt lgkmcnt(5)
  v_mfma_f32_16x16x32_bf16 v[46:49], v[224:227], v[144:147], v[46:49]
  v_cvt_pk_bf16_f32 v24, v80, v81
  s_waitcnt lgkmcnt(4)
  v_mfma_f32_16x16x32_bf16 v[46:49], v[228:231], v[148:151], v[46:49]
  v_cvt_pk_bf16_f32 v25, v82, v83
  s_waitcnt lgkmcnt(3)
  v_mfma_f32_16x16x32_bf16 v[46:49], v[232:235], v[152:155], v[46:49]
  v_cvt_pk_bf16_f32 v26, v84, v85
  s_waitcnt lgkmcnt(2)
  v_mfma_f32_16x16x32_bf16 v[46:49], v[236:239], v[156:159], v[46:49]
  v_cvt_pk_bf16_f32 v27, v86, v87
  s_waitcnt lgkmcnt(1)
  v_mfma_f32_16x16x32_bf16 v[46:49], v[240:243], v[160:163], v[46:49]
  v_pk_fma_f32 v[88:89], v[88:89], v[104:105], v[96:97]
  s_waitcnt lgkmcnt(0)
  v_mfma_f32_16x16x32_bf16 v[46:49], v[244:247], v[164:167], v[46:49]
  v_pk_fma_f32 v[90:91], v[90:91], v[106:107], v[98:99]
Lmm_e_38:
  v_pk_fma_f32 v[92:93], v[92:93], v[108:109], v[100:101]
  v_pk_fma_f32 v[94:95], v[94:95], v[110:111], v[102:103]
  v_cvt_pk_bf16_f32 v28, v88, v89
  v_cvt_pk_bf16_f32 v29, v90, v91
  v_cvt_pk_bf16_f32 v30, v92, v93
  v_cvt_pk_bf16_f32 v31, v94, v95
  s_nop 0
  v_cvt_pk_bf16_f32 v50, v46, v47
  v_cvt_pk_bf16_f32 v51, v48, v49
  s_mov_b64 exec, s[88:89]
  v_cndmask_b32 v50, v50, v44, s[78:79]
  v_cndmask_b32 v51, v51, v45, s[78:79]
  buffer_store_dwordx2 v[50:51], v43, s[24:27], s86 offen sc1
  ds_write_b64 v42, v[50:51]
  s_mov_b64 exec, -1
  ds_write_b128 v32, v[16:19]
  ds_write_b128 v33, v[20:23]
  ds_write_b128 v34, v[24:27]
  ds_write_b128 v35, v[28:31]
  s_lshl_b32 s64, s53, 6
  s_add_u32 s64, s64, 16384
  v_or_b32 v9, s60, v3
  v_mov_b32 v6, 162820
  v_mov_b32 v7, 1
  s_mov_b64 exec, 1
  s_waitcnt vmcnt(0)
  ds_add_rtn_u32 v7, v6, v7
  s_waitcnt lgkmcnt(0)
  v_cmp_eq_u32 vcc, 3, v7
  s_cbranch_vccz Lnokvf_39
  buffer_store_dword v9, off, s[24:27], s64 sc1
Lnokvf_39:
  s_waitcnt lgkmcnt(0)
  s_barrier
  s_mov_b64 exec, -1
  s_setprio 0
  s_cmp_lg_u32 s38, 1
  s_cbranch_scc1 Lcl_40
  s_add_u32 m0, s37, 0
  s_nop 0
  buffer_load_dwordx4 v203, s[16:19], s8 offen lds
  s_add_u32 m0, s37, 1088
  s_add_u32 s8, s8, s9
  buffer_load_dwordx4 v203, s[16:19], s8 offen lds
  s_add_u32 m0, s37, 2176
  s_add_u32 s8, s8, s9
  buffer_load_dwordx4 v203, s[16:19], s8 offen lds
  s_add_u32 m0, s37, 3264
  s_add_u32 s8, s8, s9
  buffer_load_dwordx4 v204, s[16:19], s8 offen lds
Lcl_40:
  s_cmp_lt_u32 s57, 14
  s_cbranch_scc1 Lre_42
  buffer_load_dwordx4 v[12:15], v2, s[32:35], 0 offen
  s_add_u32 m0, s37, 0
  s_nop 0
  buffer_load_dwordx4 v203, s[16:19], s8 offen lds
  s_add_u32 m0, s37, 1088
  s_add_u32 s8, s8, s9
  buffer_load_dwordx4 v203, s[16:19], s8 offen lds
  s_add_u32 m0, s37, 2176
  s_add_u32 s8, s8, s9
  buffer_load_dwordx4 v203, s[16:19], s8 offen lds
  s_add_u32 m0, s37, 3264
  s_add_u32 s8, s8, s9
  buffer_load_dwordx4 v204, s[16:19], s8 offen lds
  s_add_u32 s8, s8, 559104
  buffer_load_dwordx4 v[80:83], v203, s[16:19], s8 offen
  s_add_u32 s8, s8, s9
  buffer_load_dwordx4 v[84:87], v203, s[16:19], s8 offen
  s_add_u32 s8, s8, s9
  buffer_load_dwordx4 v[88:91], v203, s[16:19], s8 offen
  s_add_u32 s8, s8, s9
  buffer_load_dwordx4 v[92:95], v203, s[16:19], s8 offen
Lre_42:
  s_mul_i32 s70, s55, 7
  s_lshl_b32 s64, s52, 1
  s_add_u32 s70, s70, s64
  s_lshl_b32 s39, s70, 14
  s_add_u32 s39, s39, 524288
  s_cmp_ge_u32 s57, 7
  s_cselect_b32 s45, 1, 0
  s_cselect_b32 s64, 7, 0
  s_sub_u32 s69, s57, s64
  s_lshl_b32 s40, s69, 2
  s_add_u32 s40, s40, s52
  s_mul_i32 s40, s40, 57344
  s_add_u32 s40, s40, 4259840
  s_cmp_ge_u32 s57, 14
  s_cselect_b32 s40, 2146435072, s40
  s_mul_i32 s44, s52, 7168
  s_lshr_b32 s64, s57, 2
  s_mul_i32 s64, s64, 802816
  s_add_u32 s64, s64, s44
  s_add_u32 s64, s64, 1048576
  s_mul_i32 s65, s55, 28672
  s_add_u32 s41, s64, s65
  s_bitcmp1_b32 s52, 0
  s_cselect_b32 s63, 1024, 0
  s_mov_b32 s14, 1605632
  s_lshr_b32 s64, s52, 1
  s_mul_i32 s64, s64, 14336
  s_add_u32 s73, s63, s64
  s_lshr_b32 s64, s57, 2
  s_mul_i32 s64, s64, 7
  s_add_u32 s64, s64, s55
  s_lshl_b32 s64, s64, 7
  s_mul_i32 s63, s63, 56
  s_sub_u32 s71, s64, s63
  s_mul_i32 s63, s56, 4
  s_mul_i32 s64, s63, 9363
  s_lshr_b32 s64, s64, 16
  s_mul_i32 s64, s64, 7
  s_sub_u32 s63, s63, s64
  s_lshl_b32 s63, s63, 11
  s_add_u32 s74, s63, s73
  s_addk_i32 s63, 2048
  s_cmpk_ge_u32 s63, 14336
  s_cselect_b32 s63, 0, s63
  s_add_u32 s75, s63, s73
  s_addk_i32 s63, 2048
  s_cmpk_ge_u32 s63, 14336
  s_cselect_b32 s63, 0, s63
  s_add_u32 s76, s63, s73
  s_addk_i32 s63, 2048
  s_cmpk_ge_u32 s63, 14336
  s_cselect_b32 s63, 0, s63
  s_add_u32 s77, s63, s73
  s_addk_i32 s63, 2048
  s_cmpk_ge_u32 s63, 14336
  s_cselect_b32 s63, 0, s63
  s_add_u32 s78, s63, s73
  s_addk_i32 s63, 2048
  s_cmpk_ge_u32 s63, 14336
  s_cselect_b32 s63, 0, s63
  s_add_u32 s79, s63, s73
  s_addk_i32 s63, 2048
  s_cmpk_ge_u32 s63, 14336
  s_cselect_b32 s63, 0, s63
  s_add_u32 s80, s63, s73
  s_mul_i32 s63, s52, 7
  v_and_b32 v6, 7, v4
  v_min_u32 v6, 6, v6
  v_add_u32 v6, s63, v6
  v_mov_b32 v7, 12
  s_lshr_b32 s64, s57, 2
  s_mul_i32 s64, s64, 3
  s_add_u32 s65, s64, 2
  v_mov_b32 v8, s65
  s_mov_b32 exec_hi, 0x00ffffff
  v_mov_b32 v8, s64
  s_mov_b32 exec_hi, 0x0000ffff
  v_min_u32 v6, 13, v4
  v_lshl_add_u32 v6, s63, 1, v6
  v_mov_b32 v7, 7
  s_min_u32 s64, s69, 6
  s_add_u32 s65, s64, 512
  v_mov_b32 v8, s65
  s_mov_b32 exec_hi, 0
  v_add_u32 v6, s70, v5
  v_min_u32 v6, 27, v6
  v_lshrrev_b32 v6, 2, v6
  v_mad_u32_u24 v6, v4, 7, v6
  v_mov_b32 v7, 1
  v_mov_b32 v8, 168
  s_mov_b32 exec_hi, -1
  v_lshrrev_b32 v9, 1, v6
  v_mad_u32_u24 v8, v9, v7, v8
  v_and_b32 v6, 1, v6
  v_lshl_add_u32 v8, v6, 8, v8
  v_lshlrev_b32 v207, 6, v8
  s_lshl2_add_u32 s64, s64, 84
  v_mov_b32 v6, s64
  s_mov_b32 exec_hi, 0x0000ffff
  v_and_b32 v6, 1, v4
  v_mad_u32_u24 v6, v5, 28, v6
  v_add_u32 v6, s70, v6
  s_mov_b32 exec_hi, -1
  v_lshrrev_b32 v8, 2, v6
  v_add_u32 v8, 224, v8
  v_lshlrev_b32 v215, 6, v8
  s_cmp_lt_u32 s57, 14
  s_cbranch_scc1 Lre_44
  s_waitcnt vmcnt(8)
  v_lshlrev_b32 v64, 16, v12
  v_and_b32 v65, 0xffff0000, v12
  v_lshlrev_b32 v66, 16, v13
  v_and_b32 v67, 0xffff0000, v13
  v_lshlrev_b32 v68, 16, v14
  v_and_b32 v69, 0xffff0000, v14
  v_lshlrev_b32 v70, 16, v15
  v_and_b32 v71, 0xffff0000, v15
  v_mul_f32 v72, 0xbfb8aa3b, v64
  v_mul_f32 v73, 0xbfb8aa3b, v65
  v_mul_f32 v74, 0xbfb8aa3b, v66
  v_mul_f32 v75, 0xbfb8aa3b, v67
  v_mul_f32 v76, 0xbfb8aa3b, v68
  v_mul_f32 v77, 0xbfb8aa3b, v69
  v_mul_f32 v78, 0xbfb8aa3b, v70
  v_mul_f32 v79, 0xbfb8aa3b, v71
  v_exp_f32 v72, v72
  v_exp_f32 v73, v73
  v_exp_f32 v74, v74
  v_exp_f32 v75, v75
  v_exp_f32 v76, v76
  v_exp_f32 v77, v77
  v_exp_f32 v78, v78
  v_exp_f32 v79, v79
  v_add_f32 v72, 1.0, v72
  v_add_f32 v73, 1.0, v73
  v_add_f32 v74, 1.0, v74
  v_add_f32 v75, 1.0, v75
  v_add_f32 v76, 1.0, v76
  v_add_f32 v77, 1.0, v77
  v_add_f32 v78, 1.0, v78
  v_add_f32 v79, 1.0, v79
  v_rcp_f32 v72, v72
  v_rcp_f32 v73, v73
  v_rcp_f32 v74, v74
  v_rcp_f32 v75, v75
  v_rcp_f32 v76, v76
  v_rcp_f32 v77, v77
  v_rcp_f32 v78, v78
  v_rcp_f32 v79, v79
  v_mul_f32 v64, v64, v72
  v_mul_f32 v65, v65, v73
  v_mul_f32 v66, v66, v74
  v_mul_f32 v67, v67, v75
  v_mul_f32 v68, v68, v76
  v_mul_f32 v69, v69, v77
  v_mul_f32 v70, v70, v78
  v_mul_f32 v71, v71, v79
  v_cvt_pk_bf16_f32 v12, v64, v65
  v_cvt_pk_bf16_f32 v13, v66, v67
  v_cvt_pk_bf16_f32 v14, v68, v69
  v_cvt_pk_bf16_f32 v15, v70, v71
  v_add_u32 v6, 132096, v2
  s_lshl_b32 s63, s52, 6
  s_add_u32 s63, s63, 132096
  v_lshl_add_u32 v7, v5, 4, s63
  v_mov_b32 v8, 0
  ds_write_b128 v6, v[12:15]
  ds_write_b32 v6, v8 offset:2048
  ds_read_b128 v[16:19], v7 offset:0
  ds_read_b128 v[20:23], v7 offset:256
  ds_read_b128 v[24:27], v7 offset:512
  ds_read_b128 v[28:31], v7 offset:768
  s_waitcnt lgkmcnt(0)
Lre_44:
  s_barrier
  s_barrier
  s_setprio 3
  v_mov_b32 v6, 162816
  ds_read_b32 v9, v6
  s_cmp_ge_u32 s57, 14
  s_cbranch_scc1 Lrm_45
  s_cmp_lg_u32 s38, 1
  s_cbranch_scc1 Lcl_47
  s_waitcnt vmcnt(0)
  ds_read_b64_tr_b16 v[144:145], v205 offset:0
  ds_read_b64_tr_b16 v[146:147], v205 offset:512
  ds_read_b64_tr_b16 v[148:149], v206 offset:0
  ds_read_b64_tr_b16 v[150:151], v206 offset:512
  ds_read_b64_tr_b16 v[152:153], v205 offset:64
  ds_read_b64_tr_b16 v[154:155], v205 offset:576
  ds_read_b64_tr_b16 v[156:157], v206 offset:64
  ds_read_b64_tr_b16 v[158:159], v206 offset:576
  s_waitcnt lgkmcnt(6)
  buffer_store_dwordx4 v[144:147], v2, s[24:27], s10 offen sc1
  s_add_u32 s10, s10, s11
  s_waitcnt lgkmcnt(4)
  buffer_store_dwordx4 v[148:151], v2, s[24:27], s10 offen sc1
  s_add_u32 s10, s10, s11
  s_waitcnt lgkmcnt(2)
  buffer_store_dwordx4 v[152:155], v2, s[24:27], s10 offen sc1
  s_add_u32 s10, s10, s11
  s_waitcnt lgkmcnt(0)
  buffer_store_dwordx4 v[156:159], v2, s[24:27], s10 offen sc1
Lcl_47:
  s_mul_i32 s63, s74, 56
  s_add_u32 s63, s63, s71
  s_add_u32 m0, s74, 0
  s_nop 0
  buffer_load_dwordx4 v200, s[12:15], s63 offen lds
  s_waitcnt vmcnt(3)
  s_add_u32 m0, s74, 28672
  s_addk_i32 s63, 28672
  buffer_load_dwordx4 v200, s[12:15], s63 offen lds
  s_waitcnt vmcnt(3)
  s_add_u32 m0, s74, 57344
  s_addk_i32 s63, 28672
  buffer_load_dwordx4 v200, s[12:15], s63 offen lds
  s_waitcnt vmcnt(3)
  s_add_u32 m0, s74, 86016
  s_addk_i32 s63, 28672
  buffer_load_dwordx4 v200, s[12:15], s63 offen lds
  s_waitcnt vmcnt(3)
  s_waitcnt lgkmcnt(0)
  v_readfirstlane_b32 s61, v9
  s_mul_i32 s63, s75, 56
  s_add_u32 s63, s63, s71
  s_cmp_lg_u32 s38, 4
  s_cbranch_scc1 Lcl_48
  s_add_u32 m0, s37, 0
  s_nop 0
  buffer_load_dwordx4 v203, s[16:19], s8 offen lds
  s_waitcnt vmcnt(3)
  s_add_u32 m0, s37, 1088
  s_add_u32 s8, s8, s9
  buffer_load_dwordx4 v203, s[16:19], s8 offen lds
  s_waitcnt vmcnt(3)
  s_add_u32 m0, s37, 2176
  s_add_u32 s8, s8, s9
  buffer_load_dwordx4 v203, s[16:19], s8 offen lds
  s_waitcnt vmcnt(3)
  s_add_u32 m0, s37, 3264
  s_add_u32 s8, s8, s9
  buffer_load_dwordx4 v204, s[16:19], s8 offen lds
  s_waitcnt vmcnt(3)
Lcl_48:
  s_add_u32 m0, s75, 0
  s_nop 0
  buffer_load_dwordx4 v200, s[12:15], s63 offen lds
  s_waitcnt vmcnt(3)
  s_add_u32 m0, s75, 28672
  s_addk_i32 s63, 28672
  buffer_load_dwordx4 v200, s[12:15], s63 offen lds
  s_waitcnt vmcnt(3)
  s_cmp_lg_u32 s38, 6
  s_cbranch_scc1 Lcl_49
  s_add_u32 m0, s37, 0
  s_nop 0
  buffer_load_dwordx4 v203, s[16:19], s8 offen lds
  s_waitcnt vmcnt(3)
  s_add_u32 m0, s37, 1088
  s_add_u32 s8, s8, s9
  buffer_load_dwordx4 v203, s[16:19], s8 offen lds
  s_waitcnt vmcnt(3)
  s_add_u32 m0, s37, 2176
  s_add_u32 s8, s8, s9
  buffer_load_dwordx4 v203, s[16:19], s8 offen lds
  s_waitcnt vmcnt(3)
  s_add_u32 m0, s37, 3264
  s_add_u32 s8, s8, s9
  buffer_load_dwordx4 v204, s[16:19], s8 offen lds
  s_waitcnt vmcnt(3)
Lcl_49:
  s_add_u32 m0, s75, 57344
  s_addk_i32 s63, 28672
  buffer_load_dwordx4 v200, s[12:15], s63 offen lds
  s_waitcnt vmcnt(3)
  s_add_u32 m0, s75, 86016
  s_addk_i32 s63, 28672
  buffer_load_dwordx4 v200, s[12:15], s63 offen lds
  s_waitcnt vmcnt(3)
  s_cmp_lg_u32 s38, 1
  s_cbranch_scc1 Lcl_50
  s_mov_b64 exec, 1
  buffer_store_dword v3, off, s[24:27], s36 sc1
  s_mov_b64 exec, -1
Lcl_50:
  s_mul_i32 s63, s76, 56
  s_add_u32 s63, s63, s71
  s_cmp_lg_u32 s38, 8
  s_cbranch_scc1 Lcl_51
  s_add_u32 m0, s37, 0
  s_nop 0
  buffer_load_dwordx4 v203, s[16:19], s8 offen lds
  s_waitcnt vmcnt(3)
  s_add_u32 m0, s37, 1088
  s_add_u32 s8, s8, s9
  buffer_load_dwordx4 v203, s[16:19], s8 offen lds
  s_waitcnt vmcnt(3)
  s_add_u32 m0, s37, 2176
  s_add_u32 s8, s8, s9
  buffer_load_dwordx4 v203, s[16:19], s8 offen lds
  s_waitcnt vmcnt(3)
  s_add_u32 m0, s37, 3264
  s_add_u32 s8, s8, s9
  buffer_load_dwordx4 v204, s[16:19], s8 offen lds
  s_waitcnt vmcnt(3)
Lcl_51:
  s_add_u32 m0, s76, 0
  s_nop 0
  buffer_load_dwordx4 v200, s[12:15], s63 offen lds
  s_waitcnt vmcnt(3)
  s_add_u32 m0, s76, 28672
  s_addk_i32 s63, 28672
  buffer_load_dwordx4 v200, s[12:15], s63 offen lds
  s_waitcnt vmcnt(3)
  s_cmp_lg_u32 s38, 10
  s_cbranch_scc1 Lcl_52
  s_add_u32 m0, s37, 0
  s_nop 0
  buffer_load_dwordx4 v203, s[16:19], s8 offen lds
  s_waitcnt vmcnt(3)
  s_add_u32 m0, s37, 1088
  s_add_u32 s8, s8, s9
  buffer_load_dwordx4 v203, s[16:19], s8 offen lds
  s_waitcnt vmcnt(3)
  s_add_u32 m0, s37, 2176
  s_add_u32 s8, s8, s9
  buffer_load_dwordx4 v203, s[16:19], s8 offen lds
  s_waitcnt vmcnt(3)
  s_add_u32 m0, s37, 3264
  s_add_u32 s8, s8, s9
  buffer_load_dwordx4 v204, s[16:19], s8 offen lds
  s_waitcnt vmcnt(3)
Lcl_52:
  s_add_u32 m0, s76, 57344
  s_addk_i32 s63, 28672
  buffer_load_dwordx4 v200, s[12:15], s63 offen lds
  s_waitcnt vmcnt(3)
  s_cmp_lg_u32 s38, 4
  s_cbranch_scc1 Lcl_53
  ds_read_b64_tr_b16 v[144:145], v205 offset:0
  ds_read_b64_tr_b16 v[146:147], v205 offset:512
  ds_read_b64_tr_b16 v[148:149], v206 offset:0
  ds_read_b64_tr_b16 v[150:151], v206 offset:512
  ds_read_b64_tr_b16 v[152:153], v205 offset:64
  ds_read_b64_tr_b16 v[154:155], v205 offset:576
  ds_read_b64_tr_b16 v[156:157], v206 offset:64
  ds_read_b64_tr_b16 v[158:159], v206 offset:576
Lcl_53:
  s_add_u32 m0, s76, 86016
  s_addk_i32 s63, 28672
  buffer_load_dwordx4 v200, s[12:15], s63 offen lds
  s_waitcnt vmcnt(3)
  v_add_u32 v6, s74, v201
  v_add_u32 v7, s74, v202
  ds_read_b64_tr_b16 v[224:225], v6 offset:0
  ds_read_b64_tr_b16 v[226:227], v6 offset:512
  ds_read_b64_tr_b16 v[228:229], v7 offset:0
  ds_read_b64_tr_b16 v[230:231], v7 offset:512
  ds_read_b64_tr_b16 v[232:233], v6 offset:64
  ds_read_b64_tr_b16 v[234:235], v6 offset:576
  ds_read_b64_tr_b16 v[236:237], v7 offset:64
  ds_read_b64_tr_b16 v[238:239], v7 offset:576
  v_add_u32 v6, s74, v2
  v_add_u32 v7, 57344, v6
  s_waitcnt lgkmcnt(6)
  ds_write_b128 v6, v[224:227] offset:0
  s_waitcnt lgkmcnt(5)
  ds_write_b128 v6, v[228:231] offset:28672
  s_waitcnt lgkmcnt(4)
  ds_write_b128 v7, v[232:235] offset:0
  s_waitcnt lgkmcnt(3)
  ds_write_b128 v7, v[236:239] offset:28672
  s_mul_i32 s63, s77, 56
  s_add_u32 s63, s63, s71
  s_cmp_lg_u32 s38, 4
  s_cbranch_scc1 Lcl_54
  buffer_store_dwordx4 v[144:147], v2, s[24:27], s10 offen sc1
  s_waitcnt vmcnt(3)
  s_add_u32 s10, s10, s11
  buffer_store_dwordx4 v[148:151], v2, s[24:27], s10 offen sc1
  s_waitcnt vmcnt(3)
  s_add_u32 s10, s10, s11
  buffer_store_dwordx4 v[152:155], v2, s[24:27], s10 offen sc1
  s_waitcnt vmcnt(3)
  s_add_u32 s10, s10, s11
  buffer_store_dwordx4 v[156:159], v2, s[24:27], s10 offen sc1
  s_waitcnt vmcnt(3)
Lcl_54:
  s_add_u32 m0, s77, 0
  s_nop 0
  buffer_load_dwordx4 v200, s[12:15], s63 offen lds
  s_waitcnt vmcnt(3)
  s_cmp_lg_u32 s38, 6
  s_cbranch_scc1 Lcl_55
  ds_read_b64_tr_b16 v[144:145], v205 offset:0
  ds_read_b64_tr_b16 v[146:147], v205 offset:512
  ds_read_b64_tr_b16 v[148:149], v206 offset:0
  ds_read_b64_tr_b16 v[150:151], v206 offset:512
  ds_read_b64_tr_b16 v[152:153], v205 offset:64
  ds_read_b64_tr_b16 v[154:155], v205 offset:576
  ds_read_b64_tr_b16 v[156:157], v206 offset:64
  ds_read_b64_tr_b16 v[158:159], v206 offset:576
Lcl_55:
  s_add_u32 m0, s77, 28672
  s_addk_i32 s63, 28672
  buffer_load_dwordx4 v200, s[12:15], s63 offen lds
  s_waitcnt vmcnt(3)
  s_cmp_lg_u32 s38, 6
  s_cbranch_scc1 Lcl_56
  s_waitcnt lgkmcnt(6)
  buffer_store_dwordx4 v[144:147], v2, s[24:27], s10 offen sc1
  s_waitcnt vmcnt(3)
  s_add_u32 s10, s10, s11
  s_waitcnt lgkmcnt(4)
  buffer_store_dwordx4 v[148:151], v2, s[24:27], s10 offen sc1
  s_waitcnt vmcnt(3)
  s_add_u32 s10, s10, s11
  s_waitcnt lgkmcnt(2)
  buffer_store_dwordx4 v[152:155], v2, s[24:27], s10 offen sc1
  s_waitcnt vmcnt(3)
  s_add_u32 s10, s10, s11
  s_waitcnt lgkmcnt(0)
  buffer_store_dwordx4 v[156:159], v2, s[24:27], s10 offen sc1
  s_waitcnt vmcnt(3)
Lcl_56:
  s_add_u32 m0, s77, 57344
  s_addk_i32 s63, 28672
  buffer_load_dwordx4 v200, s[12:15], s63 offen lds
  s_waitcnt vmcnt(3)
  s_cmp_lg_u32 s38, 8
  s_cbranch_scc1 Lcl_57
  ds_read_b64_tr_b16 v[144:145], v205 offset:0
  ds_read_b64_tr_b16 v[146:147], v205 offset:512
  ds_read_b64_tr_b16 v[148:149], v206 offset:0
  ds_read_b64_tr_b16 v[150:151], v206 offset:512
  ds_read_b64_tr_b16 v[152:153], v205 offset:64
  ds_read_b64_tr_b16 v[154:155], v205 offset:576
  ds_read_b64_tr_b16 v[156:157], v206 offset:64
  ds_read_b64_tr_b16 v[158:159], v206 offset:576
Lcl_57:
  s_add_u32 m0, s77, 86016
  s_addk_i32 s63, 28672
  buffer_load_dwordx4 v200, s[12:15], s63 offen lds
  s_waitcnt vmcnt(3)
  v_add_u32 v6, s75, v201
  v_add_u32 v7, s75, v202
  ds_read_b64_tr_b16 v[240:241], v6 offset:0
  ds_read_b64_tr_b16 v[242:243], v6 offset:512
  ds_read_b64_tr_b16 v[244:245], v7 offset:0
  ds_read_b64_tr_b16 v[246:247], v7 offset:512
  ds_read_b64_tr_b16 v[248:249], v6 offset:64
  ds_read_b64_tr_b16 v[250:251], v6 offset:576
  ds_read_b64_tr_b16 v[252:253], v7 offset:64
  ds_read_b64_tr_b16 v[254:255], v7 offset:576
  v_add_u32 v6, s75, v2
  v_add_u32 v7, 57344, v6
  s_waitcnt lgkmcnt(6)
  ds_write_b128 v6, v[240:243] offset:0
  s_waitcnt lgkmcnt(5)
  ds_write_b128 v6, v[244:247] offset:28672
  s_waitcnt lgkmcnt(4)
  ds_write_b128 v7, v[248:251] offset:0
  s_waitcnt lgkmcnt(3)
  ds_write_b128 v7, v[252:255] offset:28672
  s_mul_i32 s63, s78, 56
  s_add_u32 s63, s63, s71
  s_cmp_lg_u32 s38, 8
  s_cbranch_scc1 Lcl_58
  buffer_store_dwordx4 v[144:147], v2, s[24:27], s10 offen sc1
  s_waitcnt vmcnt(3)
  s_add_u32 s10, s10, s11
  buffer_store_dwordx4 v[148:151], v2, s[24:27], s10 offen sc1
  s_waitcnt vmcnt(3)
  s_add_u32 s10, s10, s11
  buffer_store_dwordx4 v[152:155], v2, s[24:27], s10 offen sc1
  s_waitcnt vmcnt(3)
  s_add_u32 s10, s10, s11
  buffer_store_dwordx4 v[156:159], v2, s[24:27], s10 offen sc1
  s_waitcnt vmcnt(3)
Lcl_58:
  s_add_u32 m0, s78, 0
  s_nop 0
  buffer_load_dwordx4 v200, s[12:15], s63 offen lds
  s_waitcnt vmcnt(3)
  s_cmp_lg_u32 s38, 10
  s_cbranch_scc1 Lcl_59
  ds_read_b64_tr_b16 v[144:145], v205 offset:0
  ds_read_b64_tr_b16 v[146:147], v205 offset:512
  ds_read_b64_tr_b16 v[148:149], v206 offset:0
  ds_read_b64_tr_b16 v[150:151], v206 offset:512
  ds_read_b64_tr_b16 v[152:153], v205 offset:64
  ds_read_b64_tr_b16 v[154:155], v205 offset:576
  ds_read_b64_tr_b16 v[156:157], v206 offset:64
  ds_read_b64_tr_b16 v[158:159], v206 offset:576
Lcl_59:
  s_add_u32 m0, s78, 28672
  s_addk_i32 s63, 28672
  buffer_load_dwordx4 v200, s[12:15], s63 offen lds
  s_waitcnt vmcnt(3)
  s_cmp_lg_u32 s38, 10
  s_cbranch_scc1 Lcl_60
  s_waitcnt lgkmcnt(6)
  buffer_store_dwordx4 v[144:147], v2, s[24:27], s10 offen sc1
  s_waitcnt vmcnt(3)
  s_add_u32 s10, s10, s11
  s_waitcnt lgkmcnt(4)
  buffer_store_dwordx4 v[148:151], v2, s[24:27], s10 offen sc1
  s_waitcnt vmcnt(3)
  s_add_u32 s10, s10, s11
  s_waitcnt lgkmcnt(2)
  buffer_store_dwordx4 v[152:155], v2, s[24:27], s10 offen sc1
  s_waitcnt vmcnt(3)
  s_add_u32 s10, s10, s11
  s_waitcnt lgkmcnt(0)
  buffer_store_dwordx4 v[156:159], v2, s[24:27], s10 offen sc1
  s_waitcnt vmcnt(3)
Lcl_60:
  s_add_u32 m0, s78, 57344
  s_addk_i32 s63, 28672
  buffer_load_dwordx4 v200, s[12:15], s63 offen lds
  s_waitcnt vmcnt(3)
  s_add_u32 m0, s78, 86016
  s_addk_i32 s63, 28672
  buffer_load_dwordx4 v200, s[12:15], s63 offen lds
  s_waitcnt vmcnt(3)
  v_add_u32 v6, s76, v201
  v_add_u32 v7, s76, v202
  ds_read_b64_tr_b16 v[224:225], v6 offset:0
  ds_read_b64_tr_b16 v[226:227], v6 offset:512
  ds_read_b64_tr_b16 v[228:229], v7 offset:0
  ds_read_b64_tr_b16 v[230:231], v7 offset:512
  ds_read_b64_tr_b16 v[232:233], v6 offset:64
  ds_read_b64_tr_b16 v[234:235], v6 offset:576
  ds_read_b64_tr_b16 v[236:237], v7 offset:64
  ds_read_b64_tr_b16 v[238:239], v7 offset:576
  v_add_u32 v6, s76, v2
  v_add_u32 v7, 57344, v6
  s_waitcnt lgkmcnt(6)
  ds_write_b128 v6, v[224:227] offset:0
  s_waitcnt lgkmcnt(5)
  ds_write_b128 v6, v[228:231] offset:28672
  s_waitcnt lgkmcnt(4)
  ds_write_b128 v7, v[232:235] offset:0
  s_waitcnt lgkmcnt(3)
  ds_write_b128 v7, v[236:239] offset:28672
  s_mul_i32 s63, s79, 56
  s_add_u32 s63, s63, s71
  s_cmp_lg_u32 s38, 4
  s_cbranch_scc1 Lcl_61
  s_mov_b64 exec, 1
  buffer_store_dword v3, off, s[24:27], s36 sc1
  s_mov_b64 exec, -1
Lcl_61:
  s_add_u32 m0, s79, 0
  s_nop 0
  buffer_load_dwordx4 v200, s[12:15], s63 offen lds
  s_waitcnt vmcnt(3)
  s_add_u32 m0, s79, 28672
  s_addk_i32 s63, 28672
  buffer_load_dwordx4 v200, s[12:15], s63 offen lds
  s_waitcnt vmcnt(3)
  s_cmp_lg_u32 s38, 6
  s_cbranch_scc1 Lcl_62
  s_mov_b64 exec, 1
  buffer_store_dword v3, off, s[24:27], s36 sc1
  s_mov_b64 exec, -1
Lcl_62:
  s_add_u32 m0, s79, 57344
  s_addk_i32 s63, 28672
  buffer_load_dwordx4 v200, s[12:15], s63 offen lds
  s_waitcnt vmcnt(3)
  s_add_u32 m0, s79, 86016
  s_addk_i32 s63, 28672
  buffer_load_dwordx4 v200, s[12:15], s63 offen lds
  s_waitcnt vmcnt(3)
  v_add_u32 v6, s77, v201
  v_add_u32 v7, s77, v202
  ds_read_b64_tr_b16 v[240:241], v6 offset:0
  ds_read_b64_tr_b16 v[242:243], v6 offset:512
  ds_read_b64_tr_b16 v[244:245], v7 offset:0
  ds_read_b64_tr_b16 v[246:247], v7 offset:512
  ds_read_b64_tr_b16 v[248:249], v6 offset:64
  ds_read_b64_tr_b16 v[250:251], v6 offset:576
  ds_read_b64_tr_b16 v[252:253], v7 offset:64
  ds_read_b64_tr_b16 v[254:255], v7 offset:576
  v_add_u32 v6, s77, v2
  v_add_u32 v7, 57344, v6
  s_waitcnt lgkmcnt(6)
  ds_write_b128 v6, v[240:243] offset:0
  s_waitcnt lgkmcnt(5)
  ds_write_b128 v6, v[244:247] offset:28672
  s_waitcnt lgkmcnt(4)
  ds_write_b128 v7, v[248:251] offset:0
  s_waitcnt lgkmcnt(3)
  ds_write_b128 v7, v[252:255] offset:28672
  s_mov_b32 s63, 196608
  s_mov_b32 exec_hi, 3
  buffer_load_dword v213, v207, s[24:27], s63 offen sc1
  s_mov_b32 exec_hi, -1
  s_mul_i32 s63, s80, 56
  s_add_u32 s63, s63, s71
  s_cmp_lg_u32 s38, 8
  s_cbranch_scc1 Lcl_63
  s_mov_b64 exec, 1
  buffer_store_dword v3, off, s[24:27], s36 sc1
  s_mov_b64 exec, -1
Lcl_63:
  s_add_u32 m0, s80, 0
  s_nop 0
  buffer_load_dwordx4 v200, s[12:15], s63 offen lds
  s_waitcnt vmcnt(3)
  s_add_u32 m0, s80, 28672
  s_addk_i32 s63, 28672
  buffer_load_dwordx4 v200, s[12:15], s63 offen lds
  s_waitcnt vmcnt(3)
  s_cmp_lg_u32 s38, 10
  s_cbranch_scc1 Lcl_64
  s_mov_b64 exec, 1
  buffer_store_dword v3, off, s[24:27], s36 sc1
  s_mov_b64 exec, -1
Lcl_64:
  s_add_u32 m0, s80, 57344
  s_addk_i32 s63, 28672
  buffer_load_dwordx4 v200, s[12:15], s63 offen lds
  s_waitcnt vmcnt(3)
  s_add_u32 m0, s80, 86016
  s_addk_i32 s63, 28672
  buffer_load_dwordx4 v200, s[12:15], s63 offen lds
  s_waitcnt vmcnt(3)
  v_add_u32 v6, s78, v201
  v_add_u32 v7, s78, v202
  ds_read_b64_tr_b16 v[224:225], v6 offset:0
  ds_read_b64_tr_b16 v[226:227], v6 offset:512
  ds_read_b64_tr_b16 v[228:229], v7 offset:0
  ds_read_b64_tr_b16 v[230:231], v7 offset:512
  ds_read_b64_tr_b16 v[232:233], v6 offset:64
  ds_read_b64_tr_b16 v[234:235], v6 offset:576
  ds_read_b64_tr_b16 v[236:237], v7 offset:64
  ds_read_b64_tr_b16 v[238:239], v7 offset:576
  v_add_u32 v6, s78, v2
  v_add_u32 v7, 57344, v6
  s_waitcnt lgkmcnt(6)
  ds_write_b128 v6, v[224:227] offset:0
  s_waitcnt lgkmcnt(5)
  ds_write_b128 v6, v[228:231] offset:28672
  s_waitcnt lgkmcnt(4)
  ds_write_b128 v7, v[232:235] offset:0
  s_waitcnt lgkmcnt(3)
  ds_write_b128 v7, v[236:239] offset:28672
  s_branch Lre_46
Lrm_45:
  s_sub_u32 s64, s37, 21504
  v_add_u32 v8, s64, v2
  s_waitcnt vmcnt(3)
  ds_write_b128 v8, v[80:83] offset:0
  s_waitcnt vmcnt(2)
  ds_write_b128 v8, v[84:87] offset:1088
  s_waitcnt vmcnt(1)
  ds_write_b128 v8, v[88:91] offset:2176
  s_waitcnt vmcnt(0)
  ds_write_b128 v8, v[92:95] offset:3264
  ds_read_b64_tr_b16 v[48:49], v205 offset:21504
  ds_read_b64_tr_b16 v[50:51], v205 offset:22016
  ds_read_b64_tr_b16 v[52:53], v206 offset:21504
  ds_read_b64_tr_b16 v[54:55], v206 offset:22016
  ds_read_b64_tr_b16 v[56:57], v205 offset:21568
  ds_read_b64_tr_b16 v[58:59], v205 offset:22080
  ds_read_b64_tr_b16 v[60:61], v206 offset:21568
  ds_read_b64_tr_b16 v[62:63], v206 offset:22080
  s_waitcnt lgkmcnt(6)
  v_mfma_f32_16x16x32_bf16 v[32:35], v[48:51], v[16:19], 0
  s_waitcnt lgkmcnt(4)
  v_mfma_f32_16x16x32_bf16 v[36:39], v[52:55], v[16:19], 0
  s_waitcnt lgkmcnt(2)
  v_mfma_f32_16x16x32_bf16 v[40:43], v[56:59], v[16:19], 0
  s_waitcnt lgkmcnt(0)
  v_mfma_f32_16x16x32_bf16 v[44:47], v[60:63], v[16:19], 0
  s_add_u32 m0, s37, 0
  s_add_u32 s8, s8, 559104
  buffer_load_dwordx4 v203, s[16:19], s8 offen lds
  s_add_u32 m0, s37, 1088
  s_add_u32 s8, s8, s9
  buffer_load_dwordx4 v203, s[16:19], s8 offen lds
  s_add_u32 m0, s37, 2176
  s_add_u32 s8, s8, s9
  buffer_load_dwordx4 v203, s[16:19], s8 offen lds
  s_add_u32 m0, s37, 3264
  s_add_u32 s8, s8, s9
  buffer_load_dwordx4 v204, s[16:19], s8 offen lds
  s_mul_i32 s63, s74, 56
  s_add_u32 s63, s63, s71
  s_add_u32 m0, s74, 0
  s_nop 0
  buffer_load_dwordx4 v200, s[12:15], s63 offen lds
  s_waitcnt vmcnt(4)
  s_add_u32 m0, s74, 28672
  s_addk_i32 s63, 28672
  buffer_load_dwordx4 v200, s[12:15], s63 offen lds
  s_waitcnt vmcnt(4)
  s_add_u32 m0, s74, 57344
  s_addk_i32 s63, 28672
  buffer_load_dwordx4 v200, s[12:15], s63 offen lds
  s_waitcnt vmcnt(4)
  s_add_u32 m0, s74, 86016
  s_addk_i32 s63, 28672
  buffer_load_dwordx4 v200, s[12:15], s63 offen lds
  s_waitcnt vmcnt(4)
  v_readfirstlane_b32 s61, v9
  ds_read_b64_tr_b16 v[48:49], v205 offset:0
  ds_read_b64_tr_b16 v[50:51], v205 offset:512
  ds_read_b64_tr_b16 v[52:53], v206 offset:0
  ds_read_b64_tr_b16 v[54:55], v206 offset:512
  ds_read_b64_tr_b16 v[56:57], v205 offset:64
  ds_read_b64_tr_b16 v[58:59], v205 offset:576
  ds_read_b64_tr_b16 v[60:61], v206 offset:64
  ds_read_b64_tr_b16 v[62:63], v206 offset:576
  s_waitcnt lgkmcnt(6)
  v_mfma_f32_16x16x32_bf16 v[32:35], v[48:51], v[20:23], v[32:35]
  s_waitcnt lgkmcnt(4)
  v_mfma_f32_16x16x32_bf16 v[36:39], v[52:55], v[20:23], v[36:39]
  s_waitcnt lgkmcnt(2)
  v_mfma_f32_16x16x32_bf16 v[40:43], v[56:59], v[20:23], v[40:43]
  s_waitcnt lgkmcnt(0)
  v_mfma_f32_16x16x32_bf16 v[44:47], v[60:63], v[20:23], v[44:47]
  s_add_u32 m0, s37, 4294945792
  s_add_u32 s8, s8, 559104
  buffer_load_dwordx4 v203, s[16:19], s8 offen lds
  s_waitcnt vmcnt(4)
  s_add_u32 m0, s37, 4294946880
  s_add_u32 s8, s8, s9
  buffer_load_dwordx4 v203, s[16:19], s8 offen lds
  s_waitcnt vmcnt(4)
  s_add_u32 m0, s37, 4294947968
  s_add_u32 s8, s8, s9
  buffer_load_dwordx4 v203, s[16:19], s8 offen lds
  s_waitcnt vmcnt(4)
  s_add_u32 m0, s37, 4294949056
  s_add_u32 s8, s8, s9
  buffer_load_dwordx4 v204, s[16:19], s8 offen lds
  s_waitcnt vmcnt(4)
  s_mul_i32 s63, s75, 56
  s_add_u32 s63, s63, s71
  s_add_u32 m0, s75, 0
  s_nop 0
  buffer_load_dwordx4 v200, s[12:15], s63 offen lds
  s_waitcnt vmcnt(4)
  s_add_u32 m0, s75, 28672
  s_addk_i32 s63, 28672
  buffer_load_dwordx4 v200, s[12:15], s63 offen lds
  s_waitcnt vmcnt(4)
  s_add_u32 m0, s75, 57344
  s_addk_i32 s63, 28672
  buffer_load_dwordx4 v200, s[12:15], s63 offen lds
  s_waitcnt vmcnt(4)
  s_add_u32 m0, s75, 86016
  s_addk_i32 s63, 28672
  buffer_load_dwordx4 v200, s[12:15], s63 offen lds
  s_waitcnt vmcnt(4)
  ds_read_b64_tr_b16 v[48:49], v205 offset:21504
  ds_read_b64_tr_b16 v[50:51], v205 offset:22016
  ds_read_b64_tr_b16 v[52:53], v206 offset:21504
  ds_read_b64_tr_b16 v[54:55], v206 offset:22016
  ds_read_b64_tr_b16 v[56:57], v205 offset:21568
  ds_read_b64_tr_b16 v[58:59], v205 offset:22080
  ds_read_b64_tr_b16 v[60:61], v206 offset:21568
  ds_read_b64_tr_b16 v[62:63], v206 offset:22080
  s_waitcnt lgkmcnt(6)
  v_mfma_f32_16x16x32_bf16 v[32:35], v[48:51], v[24:27], v[32:35]
  s_waitcnt lgkmcnt(4)
  v_mfma_f32_16x16x32_bf16 v[36:39], v[52:55], v[24:27], v[36:39]
  s_waitcnt lgkmcnt(2)
  v_mfma_f32_16x16x32_bf16 v[40:43], v[56:59], v[24:27], v[40:43]
  s_waitcnt lgkmcnt(0)
  v_mfma_f32_16x16x32_bf16 v[44:47], v[60:63], v[24:27], v[44:47]
  s_mul_i32 s63, s76, 56
  s_add_u32 s63, s63, s71
  s_add_u32 m0, s76, 0
  s_nop 0
  buffer_load_dwordx4 v200, s[12:15], s63 offen lds
  s_waitcnt vmcnt(4)
  s_add_u32 m0, s76, 28672
  s_addk_i32 s63, 28672
  buffer_load_dwordx4 v200, s[12:15], s63 offen lds
  s_waitcnt vmcnt(4)
  s_add_u32 m0, s76, 57344
  s_addk_i32 s63, 28672
  buffer_load_dwordx4 v200, s[12:15], s63 offen lds
  s_waitcnt vmcnt(4)
  s_add_u32 m0, s76, 86016
  s_addk_i32 s63, 28672
  buffer_load_dwordx4 v200, s[12:15], s63 offen lds
  s_waitcnt vmcnt(4)
  v_add_u32 v6, s74, v201
  v_add_u32 v7, s74, v202
  ds_read_b64_tr_b16 v[224:225], v6 offset:0
  ds_read_b64_tr_b16 v[226:227], v6 offset:512
  ds_read_b64_tr_b16 v[228:229], v7 offset:0
  ds_read_b64_tr_b16 v[230:231], v7 offset:512
  ds_read_b64_tr_b16 v[232:233], v6 offset:64
  ds_read_b64_tr_b16 v[234:235], v6 offset:576
  ds_read_b64_tr_b16 v[236:237], v7 offset:64
  ds_read_b64_tr_b16 v[238:239], v7 offset:576
  v_add_u32 v6, s74, v2
  v_add_u32 v7, 57344, v6
  s_waitcnt lgkmcnt(6)
  ds_write_b128 v6, v[224:227] offset:0
  s_waitcnt lgkmcnt(5)
  ds_write_b128 v6, v[228:231] offset:28672
  s_waitcnt lgkmcnt(4)
  ds_write_b128 v7, v[232:235] offset:0
  s_waitcnt lgkmcnt(3)
  ds_write_b128 v7, v[236:239] offset:28672
  ds_read_b64_tr_b16 v[48:49], v205 offset:0
  ds_read_b64_tr_b16 v[50:51], v205 offset:512
  ds_read_b64_tr_b16 v[52:53], v206 offset:0
  ds_read_b64_tr_b16 v[54:55], v206 offset:512
  ds_read_b64_tr_b16 v[56:57], v205 offset:64
  ds_read_b64_tr_b16 v[58:59], v205 offset:576
  ds_read_b64_tr_b16 v[60:61], v206 offset:64
  ds_read_b64_tr_b16 v[62:63], v206 offset:576
  s_waitcnt lgkmcnt(6)
  v_mfma_f32_16x16x32_bf16 v[32:35], v[48:51], v[28:31], v[32:35]
  s_waitcnt lgkmcnt(4)
  v_mfma_f32_16x16x32_bf16 v[36:39], v[52:55], v[28:31], v[36:39]
  s_waitcnt lgkmcnt(2)
  v_mfma_f32_16x16x32_bf16 v[40:43], v[56:59], v[28:31], v[40:43]
  s_waitcnt lgkmcnt(0)
  v_mfma_f32_16x16x32_bf16 v[44:47], v[60:63], v[28:31], v[44:47]
  s_lshl_b32 s63, s52, 8
  s_add_u32 s63, s63, 132096
  v_lshl_add_u32 v6, v5, 4, s63
  v_mov_b32 v7, 132096
  v_mov_b32 v8, 1
  s_mov_b32 exec_lo, 0x00010001
  s_mov_b32 exec_hi, 0x00010001
  ds_write_b128 v6, v[32:35] offset:1024
  ds_write_b128 v6, v[36:39] offset:1088
  ds_write_b128 v6, v[40:43] offset:1152
  ds_write_b128 v6, v[44:47] offset:1216
  s_mov_b64 exec, 1
  ds_add_rtn_u32 v8, v7, v8 offset:2048
  s_mov_b64 exec, -1
  v_lshl_add_u32 v7, v1, 2, v7
  s_waitcnt lgkmcnt(0)
  v_readfirstlane_b32 s63, v8
  s_nop 0
  s_cmp_eq_u32 s63, 3
  s_cselect_b32 s36, s36, 2146435072
  s_cbranch_scc0 Lm2x_65
  ds_read_b32 v48, v7 offset:1024
  ds_read_b32 v49, v7 offset:1280
  ds_read_b32 v50, v7 offset:1536
  ds_read_b32 v51, v7 offset:1792
  v_lshlrev_b32 v6, 1, v1
  s_waitcnt lgkmcnt(2)
  v_add_f32 v48, v48, v49
  s_waitcnt lgkmcnt(0)
  v_add_f32 v50, v50, v51
  v_add_f32 v48, v48, v50
  v_cvt_pk_bf16_f32 v48, v48, v48
  buffer_store_short v48, v6, s[24:27], s10 offen sc1
Lm2x_65:
  s_mul_i32 s63, s77, 56
  s_add_u32 s63, s63, s71
  s_add_u32 m0, s77, 0
  s_nop 0
  buffer_load_dwordx4 v200, s[12:15], s63 offen lds
  s_waitcnt vmcnt(4)
  s_add_u32 m0, s77, 28672
  s_addk_i32 s63, 28672
  buffer_load_dwordx4 v200, s[12:15], s63 offen lds
  s_waitcnt vmcnt(4)
  s_add_u32 m0, s77, 57344
  s_addk_i32 s63, 28672
  buffer_load_dwordx4 v200, s[12:15], s63 offen lds
  s_waitcnt vmcnt(4)
  s_add_u32 m0, s77, 86016
  s_addk_i32 s63, 28672
  buffer_load_dwordx4 v200, s[12:15], s63 offen lds
  s_waitcnt vmcnt(4)
  v_add_u32 v6, s75, v201
  v_add_u32 v7, s75, v202
  ds_read_b64_tr_b16 v[240:241], v6 offset:0
  ds_read_b64_tr_b16 v[242:243], v6 offset:512
  ds_read_b64_tr_b16 v[244:245], v7 offset:0
  ds_read_b64_tr_b16 v[246:247], v7 offset:512
  ds_read_b64_tr_b16 v[248:249], v6 offset:64
  ds_read_b64_tr_b16 v[250:251], v6 offset:576
  ds_read_b64_tr_b16 v[252:253], v7 offset:64
  ds_read_b64_tr_b16 v[254:255], v7 offset:576
  v_add_u32 v6, s75, v2
  v_add_u32 v7, 57344, v6
  s_waitcnt lgkmcnt(6)
  ds_write_b128 v6, v[240:243] offset:0
  s_waitcnt lgkmcnt(5)
  ds_write_b128 v6, v[244:247] offset:28672
  s_waitcnt lgkmcnt(4)
  ds_write_b128 v7, v[248:251] offset:0
  s_waitcnt lgkmcnt(3)
  ds_write_b128 v7, v[252:255] offset:28672
  s_mul_i32 s63, s78, 56
  s_add_u32 s63, s63, s71
  s_add_u32 m0, s78, 0
  s_nop 0
  buffer_load_dwordx4 v200, s[12:15], s63 offen lds
  s_waitcnt vmcnt(4)
  s_add_u32 m0, s78, 28672
  s_addk_i32 s63, 28672
  buffer_load_dwordx4 v200, s[12:15], s63 offen lds
  s_waitcnt vmcnt(4)
  s_add_u32 m0, s78, 57344
  s_addk_i32 s63, 28672
  buffer_load_dwordx4 v200, s[12:15], s63 offen lds
  s_waitcnt vmcnt(4)
  s_add_u32 m0, s78, 86016
  s_addk_i32 s63, 28672
  buffer_load_dwordx4 v200, s[12:15], s63 offen lds
  s_waitcnt vmcnt(4)
  v_add_u32 v6, s76, v201
  v_add_u32 v7, s76, v202
  ds_read_b64_tr_b16 v[224:225], v6 offset:0
  ds_read_b64_tr_b16 v[226:227], v6 offset:512
  ds_read_b64_tr_b16 v[228:229], v7 offset:0
  ds_read_b64_tr_b16 v[230:231], v7 offset:512
  ds_read_b64_tr_b16 v[232:233], v6 offset:64
  ds_read_b64_tr_b16 v[234:235], v6 offset:576
  ds_read_b64_tr_b16 v[236:237], v7 offset:64
  ds_read_b64_tr_b16 v[238:239], v7 offset:576
  v_add_u32 v6, s76, v2
  v_add_u32 v7, 57344, v6
  s_waitcnt lgkmcnt(6)
  ds_write_b128 v6, v[224:227] offset:0
  s_waitcnt lgkmcnt(5)
  ds_write_b128 v6, v[228:231] offset:28672
  s_waitcnt lgkmcnt(4)
  ds_write_b128 v7, v[232:235] offset:0
  s_waitcnt lgkmcnt(3)
  ds_write_b128 v7, v[236:239] offset:28672
  s_mov_b64 exec, 1
  buffer_store_dword v3, off, s[24:27], s36 sc1
  s_mov_b64 exec, -1
  s_mul_i32 s63, s79, 56
  s_add_u32 s63, s63, s71
  s_add_u32 m0, s79, 0
  s_nop 0
  buffer_load_dwordx4 v200, s[12:15], s63 offen lds
  s_waitcnt vmcnt(4)
  s_add_u32 m0, s79, 28672
  s_addk_i32 s63, 28672
  buffer_load_dwordx4 v200, s[12:15], s63 offen lds
  s_waitcnt vmcnt(4)
  s_add_u32 m0, s79, 57344
  s_addk_i32 s63, 28672
  buffer_load_dwordx4 v200, s[12:15], s63 offen lds
  s_waitcnt vmcnt(4)
  s_add_u32 m0, s79, 86016
  s_addk_i32 s63, 28672
  buffer_load_dwordx4 v200, s[12:15], s63 offen lds
  s_waitcnt vmcnt(4)
  v_add_u32 v6, s77, v201
  v_add_u32 v7, s77, v202
  ds_read_b64_tr_b16 v[240:241], v6 offset:0
  ds_read_b64_tr_b16 v[242:243], v6 offset:512
  ds_read_b64_tr_b16 v[244:245], v7 offset:0
  ds_read_b64_tr_b16 v[246:247], v7 offset:512
  ds_read_b64_tr_b16 v[248:249], v6 offset:64
  ds_read_b64_tr_b16 v[250:251], v6 offset:576
  ds_read_b64_tr_b16 v[252:253], v7 offset:64
  ds_read_b64_tr_b16 v[254:255], v7 offset:576
  v_add_u32 v6, s77, v2
  v_add_u32 v7, 57344, v6
  s_waitcnt lgkmcnt(6)
  ds_write_b128 v6, v[240:243] offset:0
  s_waitcnt lgkmcnt(5)
  ds_write_b128 v6, v[244:247] offset:28672
  s_waitcnt lgkmcnt(4)
  ds_write_b128 v7, v[248:251] offset:0
  s_waitcnt lgkmcnt(3)
  ds_write_b128 v7, v[252:255] offset:28672
  s_mov_b32 s63, 196608
  s_mov_b32 exec_hi, 3
  buffer_load_dword v213, v207, s[24:27], s63 offen sc1
  s_mov_b32 exec_hi, -1
  s_mul_i32 s63, s80, 56
  s_add_u32 s63, s63, s71
  s_add_u32 m0, s80, 0
  s_nop 0
  buffer_load_dwordx4 v200, s[12:15], s63 offen lds
  s_waitcnt vmcnt(4)
  s_add_u32 m0, s80, 28672
  s_addk_i32 s63, 28672
  buffer_load_dwordx4 v200, s[12:15], s63 offen lds
  s_waitcnt vmcnt(4)
  s_add_u32 m0, s80, 57344
  s_addk_i32 s63, 28672
  buffer_load_dwordx4 v200, s[12:15], s63 offen lds
  s_waitcnt vmcnt(4)
  s_add_u32 m0, s80, 86016
  s_addk_i32 s63, 28672
  buffer_load_dwordx4 v200, s[12:15], s63 offen lds
  s_waitcnt vmcnt(4)
  v_add_u32 v6, s78, v201
  v_add_u32 v7, s78, v202
  ds_read_b64_tr_b16 v[224:225], v6 offset:0
  ds_read_b64_tr_b16 v[226:227], v6 offset:512
  ds_read_b64_tr_b16 v[228:229], v7 offset:0
  ds_read_b64_tr_b16 v[230:231], v7 offset:512
  ds_read_b64_tr_b16 v[232:233], v6 offset:64
  ds_read_b64_tr_b16 v[234:235], v6 offset:576
  ds_read_b64_tr_b16 v[236:237], v7 offset:64
  ds_read_b64_tr_b16 v[238:239], v7 offset:576
  v_add_u32 v6, s78, v2
  v_add_u32 v7, 57344, v6
  s_waitcnt lgkmcnt(6)
  ds_write_b128 v6, v[224:227] offset:0
  s_waitcnt lgkmcnt(5)
  ds_write_b128 v6, v[228:231] offset:28672
  s_waitcnt lgkmcnt(4)
  ds_write_b128 v7, v[232:235] offset:0
  s_waitcnt lgkmcnt(3)
  ds_write_b128 v7, v[236:239] offset:28672
Lre_46:
  v_lshrrev_b32 v6, 5, v1
  v_and_b32 v7, 31, v1
  v_mul_u32_u24 v7, 896, v7
  v_lshl_add_u32 v7, v6, 4, v7
  s_mul_i32 s63, s54, 28672
  s_lshl_b32 s64, s70, 5
  s_add_u32 s63, s63, s64
  s_cmp_eq_u32 s52, 3
  s_cselect_b32 s65, 2146435072, s63
  buffer_load_dwordx4 v[216:219], v7, s[4:7], s63 offen
  buffer_load_dwordx4 v[220:223], v7, s[4:7], s65 offen offset:32
  s_mov_b32 s65, 16384
  s_cmov_b32 s65, 2146435072
  v_lshlrev_b32 v15, 4, v6
  v_and_b32 v7, 1, v5
  v_mul_lo_u32 v7, v7, s65
  v_lshl_add_u32 v7, v6, 8, v7
  v_lshl_add_u32 v11, v4, 4, v7
  v_lshlrev_b32 v10, 4, v4
  v_lshl_add_u32 v10, v5, 9, v10
  v_add_u32 v12, 114688, v2
  s_add_u32 s72, s64, 8192
  s_mov_b32 s71, 196608
  s_mov_b32 exec_hi, 3
  v_cmp_ne_u32 vcc, v3, v213
  s_cbranch_vccz Lfok_66
Lpoll_67:
  buffer_load_dword v213, v207, s[24:27], s71 offen sc1
  s_sub_u32 s59, s59, 1
  s_cmp_lt_i32 s59, 0
  s_cbranch_scc1 Lpdone_68
  s_waitcnt vmcnt(0)
  v_cmp_ne_u32 vcc, v3, v213
  s_cbranch_vccnz Lpoll_67
Lpdone_68:
Lfok_66:
  s_mov_b32 exec_hi, -1
  v_add_u32 v6, 64, v207
  v_mov_b32 v7, v6
  s_nop 1
  v_permlane32_swap_b32 v6, v7
  s_mov_b64 exec, 0x00ff0000
  v_mov_b32 v207, v7
  s_mov_b64 exec, -1
  s_add_u32 s81, s55, 0
  s_and_b32 s81, s81, 3
  s_lshl_b32 s81, s81, 12
  s_add_u32 s81, s81, s39
  buffer_load_dwordx4 v[16:19], v11, s[24:27], s81 offen offset:0 sc1
  s_waitcnt vmcnt(3)
  buffer_load_dwordx4 v[20:23], v11, s[24:27], s81 offen offset:512 sc1
  s_waitcnt vmcnt(3)
  v_add_u32 v6, s79, v201
  v_add_u32 v7, s79, v202
  ds_read_b64_tr_b16 v[240:241], v6 offset:0
  ds_read_b64_tr_b16 v[242:243], v6 offset:512
  ds_read_b64_tr_b16 v[244:245], v7 offset:0
  ds_read_b64_tr_b16 v[246:247], v7 offset:512
  ds_read_b64_tr_b16 v[248:249], v6 offset:64
  ds_read_b64_tr_b16 v[250:251], v6 offset:576
  ds_read_b64_tr_b16 v[252:253], v7 offset:64
  ds_read_b64_tr_b16 v[254:255], v7 offset:576
  v_add_u32 v6, s79, v2
  v_add_u32 v7, 57344, v6
  s_waitcnt lgkmcnt(6)
  ds_write_b128 v6, v[240:243] offset:0
  s_waitcnt lgkmcnt(5)
  ds_write_b128 v6, v[244:247] offset:28672
  s_waitcnt lgkmcnt(4)
  ds_write_b128 v7, v[248:251] offset:0
  s_waitcnt lgkmcnt(3)
  ds_write_b128 v7, v[252:255] offset:28672
  buffer_load_dwordx4 v[24:27], v11, s[24:27], s81 offen offset:1024 sc1
  s_waitcnt vmcnt(3)
  buffer_load_dwordx4 v[28:31], v11, s[24:27], s81 offen offset:1536 sc1
  s_waitcnt vmcnt(3)
  buffer_load_dwordx4 v[32:35], v11, s[24:27], s81 offen offset:2048 sc1
  s_waitcnt vmcnt(3)
  v_add_u32 v6, s80, v201
  v_add_u32 v7, s80, v202
  ds_read_b64_tr_b16 v[224:225], v6 offset:0
  ds_read_b64_tr_b16 v[226:227], v6 offset:512
  ds_read_b64_tr_b16 v[228:229], v7 offset:0
  ds_read_b64_tr_b16 v[230:231], v7 offset:512
  ds_read_b64_tr_b16 v[232:233], v6 offset:64
  ds_read_b64_tr_b16 v[234:235], v6 offset:576
  ds_read_b64_tr_b16 v[236:237], v7 offset:64
  ds_read_b64_tr_b16 v[238:239], v7 offset:576
  v_add_u32 v6, s80, v2
  v_add_u32 v7, 57344, v6
  s_waitcnt lgkmcnt(6)
  ds_write_b128 v6, v[224:227] offset:0
  s_waitcnt lgkmcnt(5)
  ds_write_b128 v6, v[228:231] offset:28672
  s_waitcnt lgkmcnt(4)
  ds_write_b128 v7, v[232:235] offset:0
  s_waitcnt lgkmcnt(3)
  ds_write_b128 v7, v[236:239] offset:28672
  buffer_load_dwordx4 v[36:39], v11, s[24:27], s81 offen offset:2560 sc1
  s_waitcnt vmcnt(3)
  buffer_load_dwordx4 v[40:43], v11, s[24:27], s81 offen offset:3072 sc1
  s_waitcnt vmcnt(3)
  s_waitcnt lgkmcnt(0)
  s_barrier
  buffer_load_dwordx4 v[44:47], v11, s[24:27], s81 offen offset:3584 sc1
  s_waitcnt vmcnt(20)
  buffer_load_dword v8, v215, s[24:27], s71 offen sc1
  s_add_u32 s81, s55, 1
  s_and_b32 s81, s81, 3
  s_lshl_b32 s81, s81, 12
  s_add_u32 s81, s81, s39
  buffer_load_dwordx4 v[48:51], v11, s[24:27], s81 offen offset:0 sc1
  s_waitcnt vmcnt(20)
  buffer_load_dwordx4 v[52:55], v11, s[24:27], s81 offen offset:512 sc1
  s_waitcnt vmcnt(20)
  buffer_load_dwordx4 v[56:59], v11, s[24:27], s81 offen offset:1024 sc1
  s_waitcnt vmcnt(20)
  buffer_load_dwordx4 v[60:63], v11, s[24:27], s81 offen offset:1536 sc1
  s_waitcnt vmcnt(20)
  buffer_load_dwordx4 v[64:67], v11, s[24:27], s81 offen offset:2048 sc1
  s_waitcnt vmcnt(20)
  buffer_load_dwordx4 v[68:71], v11, s[24:27], s81 offen offset:2560 sc1
  s_waitcnt vmcnt(20)
  buffer_load_dwordx4 v[72:75], v11, s[24:27], s81 offen offset:3072 sc1
  s_waitcnt vmcnt(20)
  buffer_load_dwordx4 v[76:79], v11, s[24:27], s81 offen offset:3584 sc1
  s_waitcnt vmcnt(20)
  s_add_u32 s81, s55, 2
  s_and_b32 s81, s81, 3
  s_lshl_b32 s81, s81, 12
  s_add_u32 s81, s81, s39
  buffer_load_dwordx4 v[80:83], v11, s[24:27], s81 offen offset:0 sc1
  s_waitcnt vmcnt(20)
  buffer_load_dwordx4 v[84:87], v11, s[24:27], s81 offen offset:512 sc1
  s_waitcnt vmcnt(20)
  buffer_load_dwordx4 v[88:91], v11, s[24:27], s81 offen offset:1024 sc1
  s_waitcnt vmcnt(20)
  buffer_load_dwordx4 v[92:95], v11, s[24:27], s81 offen offset:1536 sc1
  s_waitcnt vmcnt(20)
  buffer_load_dwordx4 v[96:99], v11, s[24:27], s81 offen offset:2048 sc1
  s_waitcnt vmcnt(20)
  buffer_load_dwordx4 v[100:103], v11, s[24:27], s81 offen offset:2560 sc1
  s_waitcnt vmcnt(20)
  buffer_load_dwordx4 v[104:107], v11, s[24:27], s81 offen offset:3072 sc1
  s_waitcnt vmcnt(20)
  buffer_load_dwordx4 v[108:111], v11, s[24:27], s81 offen offset:3584 sc1
  s_waitcnt vmcnt(20)
  s_add_u32 s81, s55, 3
  s_and_b32 s81, s81, 3
  s_lshl_b32 s81, s81, 12
  s_add_u32 s81, s81, s39
  buffer_load_dwordx4 v[112:115], v11, s[24:27], s81 offen offset:0 sc1
  s_waitcnt vmcnt(20)
  buffer_load_dwordx4 v[116:119], v11, s[24:27], s81 offen offset:512 sc1
  s_waitcnt vmcnt(20)
  buffer_load_dwordx4 v[120:123], v11, s[24:27], s81 offen offset:1024 sc1
  s_waitcnt vmcnt(20)
  buffer_load_dwordx4 v[124:127], v11, s[24:27], s81 offen offset:1536 sc1
  s_waitcnt vmcnt(20)
  buffer_load_dwordx4 v[128:131], v11, s[24:27], s81 offen offset:2048 sc1
  s_waitcnt vmcnt(20)
  buffer_load_dwordx4 v[132:135], v11, s[24:27], s81 offen offset:2560 sc1
  s_waitcnt vmcnt(20)
  buffer_load_dwordx4 v[136:139], v11, s[24:27], s81 offen offset:3072 sc1
  s_waitcnt vmcnt(20)
  buffer_load_dwordx4 v[140:143], v11, s[24:27], s81 offen offset:3584 sc1
  s_waitcnt vmcnt(20)
  s_cmp_ge_u32 s52, 2
  s_cbranch_scc1 Lnotouch_69
  v_lshlrev_b32 v6, 7, v1
  s_lshl_b32 s65, s53, 13
  s_add_u32 s65, s65, 6291456
  s_cmp_eq_u32 s52, 0
  s_cbranch_scc1 Lnotouch_69_go
  s_lshl_b32 s65, s53, 9
  s_add_u32 s65, s65, 65536
  v_add_u32 v6, s65, v6
  s_lshl_b32 s65, s53, 4
  s_add_u32 s65, s65, 16384
  v_lshl_add_u32 v7, v1, 12, s65
  v_cmp_lt_u32 vcc, 3, v1
  s_nop 1
  v_cndmask_b32 v6, v6, v7, vcc
  v_mov_b32 v7, 2146435072
  v_cmp_lt_u32 vcc, 6, v1
  s_nop 1
  v_cndmask_b32 v6, v6, v7, vcc
  s_mov_b32 s65, 0
Lnotouch_69_go:
  buffer_load_dword v214, v6, s[24:27], s65 offen sc1
Lnotouch_69:
  v_cmp_ne_u32 vcc, v3, v8
  s_cbranch_vccz Lfok_72
Lpoll_73:
  buffer_load_dword v8, v215, s[24:27], s71 offen sc1
  s_sub_u32 s59, s59, 1
  s_cmp_lt_i32 s59, 0
  s_cbranch_scc1 Lpdone_74
  s_waitcnt vmcnt(0)
  v_cmp_ne_u32 vcc, v3, v8
  s_cbranch_vccnz Lpoll_73
Lpdone_74:
Lfok_72:
  buffer_load_dwordx4 v[192:195], v15, s[24:27], s72 offen offset:0 sc1
  s_waitcnt vmcnt(20)
  buffer_load_dwordx4 v[196:199], v15, s[24:27], s72 offen offset:32 sc1
  s_waitcnt vmcnt(20)
  buffer_load_dwordx4 v[176:179], v15, s[24:27], s72 offen offset:896 sc1
  s_waitcnt vmcnt(20)
  buffer_load_dwordx4 v[180:183], v15, s[24:27], s72 offen offset:928 sc1
  s_waitcnt vmcnt(20)
  buffer_load_dwordx4 v[184:187], v15, s[24:27], s72 offen offset:1792 sc1
  s_waitcnt vmcnt(20)
  buffer_load_dwordx4 v[188:191], v15, s[24:27], s72 offen offset:1824 sc1
  s_waitcnt vmcnt(20)
  s_cmp_ge_u32 s57, 14
  s_cbranch_scc1 Lnowd01
  s_add_u32 s68, s40, 0
  buffer_load_dwordx4 v[224:227], v2, s[24:27], s68 offen offset:0 sc1
  s_waitcnt vmcnt(20)
  buffer_load_dwordx4 v[228:231], v2, s[24:27], s68 offen offset:1024 sc1
  s_waitcnt vmcnt(20)
  buffer_load_dwordx4 v[232:235], v2, s[24:27], s68 offen offset:2048 sc1
  s_waitcnt vmcnt(20)
  buffer_load_dwordx4 v[236:239], v2, s[24:27], s68 offen offset:3072 sc1
  s_waitcnt vmcnt(20)
  s_add_u32 s68, s40, 4096
  buffer_load_dwordx4 v[240:243], v2, s[24:27], s68 offen offset:0 sc1
  s_waitcnt vmcnt(20)
  buffer_load_dwordx4 v[244:247], v2, s[24:27], s68 offen offset:1024 sc1
  s_waitcnt vmcnt(20)
  buffer_load_dwordx4 v[248:251], v2, s[24:27], s68 offen offset:2048 sc1
  s_waitcnt vmcnt(20)
  buffer_load_dwordx4 v[252:255], v2, s[24:27], s68 offen offset:3072 sc1
  s_waitcnt vmcnt(20)
Lnowd01:
  buffer_load_dword v215, v207, s[24:27], s71 offen sc1
  s_waitcnt lgkmcnt(0)
  s_barrier
  s_waitcnt vmcnt(6)
  v_lshlrev_b32 v144, 16, v192
  v_and_b32 v145, 0xffff0000, v192
  v_lshlrev_b32 v160, 16, v216
  v_and_b32 v161, 0xffff0000, v216
  v_lshlrev_b32 v146, 16, v193
  v_and_b32 v147, 0xffff0000, v193
  v_lshlrev_b32 v162, 16, v217
  v_and_b32 v163, 0xffff0000, v217
  v_lshlrev_b32 v148, 16, v194
  v_and_b32 v149, 0xffff0000, v194
  v_lshlrev_b32 v164, 16, v218
  v_and_b32 v165, 0xffff0000, v218
  v_lshlrev_b32 v150, 16, v195
  v_and_b32 v151, 0xffff0000, v195
  v_lshlrev_b32 v166, 16, v219
  v_and_b32 v167, 0xffff0000, v219
  s_waitcnt vmcnt(5)
  v_lshlrev_b32 v152, 16, v196
  v_and_b32 v153, 0xffff0000, v196
  v_lshlrev_b32 v168, 16, v220
  v_and_b32 v169, 0xffff0000, v220
  v_lshlrev_b32 v154, 16, v197
  v_and_b32 v155, 0xffff0000, v197
  v_lshlrev_b32 v170, 16, v221
  v_and_b32 v171, 0xffff0000, v221
  v_lshlrev_b32 v156, 16, v198
  v_and_b32 v157, 0xffff0000, v198
  v_lshlrev_b32 v172, 16, v222
  v_and_b32 v173, 0xffff0000, v222
  v_lshlrev_b32 v158, 16, v199
  v_and_b32 v159, 0xffff0000, v199
  v_lshlrev_b32 v174, 16, v223
  v_and_b32 v175, 0xffff0000, v223
  s_waitcnt vmcnt(0)
  v_cmp_ne_u32 vcc, v3, v215
  s_cbranch_vccz Lfok_75
Lpoll_76:
  buffer_load_dword v215, v207, s[24:27], s71 offen sc1
  s_sub_u32 s59, s59, 1
  s_cmp_lt_i32 s59, 0
  s_cbranch_scc1 Lpdone_77
  s_waitcnt vmcnt(0)
  v_cmp_ne_u32 vcc, v3, v215
  s_cbranch_vccnz Lpoll_76
Lpdone_77:
Lfok_75:
  s_setprio 2
  s_lshl_b32 s8, s70, 10
  s_add_u32 s9, s8, 1024
  s_cmp_eq_u32 s52, 3
  s_cselect_b32 s9, 2129657856, s9
  s_lshl_b32 s65, s52, 8
  s_add_u32 s65, s65, 159744
  v_lshl_add_u32 v8, v1, 2, s65
  v_lshlrev_b32 v9, 2, v1
  v_add_u32 v9, 159744, v9
  v_lshlrev_b32 v15, 3, v1
  s_lshl_b32 s10, s54, 11
  s_add_u32 s10, s10, 65536
  s_lshl_b32 s66, s55, 9
  s_add_u32 s11, s10, s66
  s_cmp_eq_u32 s52, 0
  s_cselect_b32 s11, s11, 2146435072
  s_barrier
  ds_read_b128 v[208:211], v12 offset:0
  s_waitcnt vmcnt(0)
  ds_read_b128 v[212:215], v12 offset:1024
  ds_read_b128 v[216:219], v12 offset:12288
  ds_read_b128 v[220:223], v12 offset:13312
  s_waitcnt lgkmcnt(3)
  v_mfma_f32_32x32x16_bf16 v[192:207], v[16:19], v[208:211], 0
  ds_read_b128 v[208:211], v12 offset:24576
  s_waitcnt lgkmcnt(3)
  v_mfma_f32_32x32x16_bf16 v[192:207], v[20:23], v[212:215], v[192:207]
  ds_read_b128 v[212:215], v12 offset:25600
  s_waitcnt lgkmcnt(3)
  v_mfma_f32_32x32x16_bf16 v[192:207], v[24:27], v[216:219], v[192:207]
  ds_read_b128 v[216:219], v12 offset:36864
  s_waitcnt lgkmcnt(3)
  v_mfma_f32_32x32x16_bf16 v[192:207], v[28:31], v[220:223], v[192:207]
  ds_read_b128 v[220:223], v12 offset:37888
  s_waitcnt lgkmcnt(3)
  v_mfma_f32_32x32x16_bf16 v[192:207], v[32:35], v[208:211], v[192:207]
  s_waitcnt lgkmcnt(2)
  v_mfma_f32_32x32x16_bf16 v[192:207], v[36:39], v[212:215], v[192:207]
  s_waitcnt lgkmcnt(1)
  v_mfma_f32_32x32x16_bf16 v[192:207], v[40:43], v[216:219], v[192:207]
  s_waitcnt lgkmcnt(0)
  v_mfma_f32_32x32x16_bf16 v[192:207], v[44:47], v[220:223], v[192:207]
  s_barrier
  ds_read_b128 v[208:211], v12 offset:2048
  ds_read_b128 v[212:215], v12 offset:3072
  ds_read_b128 v[216:219], v12 offset:14336
  ds_read_b128 v[220:223], v12 offset:15360
  s_waitcnt lgkmcnt(3)
  v_mfma_f32_32x32x16_bf16 v[192:207], v[48:51], v[208:211], v[192:207]
  s_add_u32 s68, s40, 8192
  buffer_load_dwordx4 v[16:19], v2, s[24:27], s68 offen offset:0 sc1
  ds_read_b128 v[208:211], v12 offset:26624
  s_waitcnt lgkmcnt(3)
  v_mfma_f32_32x32x16_bf16 v[192:207], v[52:55], v[212:215], v[192:207]
  buffer_load_dwordx4 v[20:23], v2, s[24:27], s68 offen offset:1024 sc1
  ds_read_b128 v[212:215], v12 offset:27648
  s_waitcnt lgkmcnt(3)
  v_mfma_f32_32x32x16_bf16 v[192:207], v[56:59], v[216:219], v[192:207]
  buffer_load_dwordx4 v[24:27], v2, s[24:27], s68 offen offset:2048 sc1
  ds_read_b128 v[216:219], v12 offset:38912
  s_waitcnt lgkmcnt(3)
  v_mfma_f32_32x32x16_bf16 v[192:207], v[60:63], v[220:223], v[192:207]
  buffer_load_dwordx4 v[28:31], v2, s[24:27], s68 offen offset:3072 sc1
  ds_read_b128 v[220:223], v12 offset:39936
  s_waitcnt lgkmcnt(3)
  v_mfma_f32_32x32x16_bf16 v[192:207], v[64:67], v[208:211], v[192:207]
  s_add_u32 s68, s40, 12288
  buffer_load_dwordx4 v[32:35], v2, s[24:27], s68 offen offset:0 sc1
  ds_read_b128 v[208:211], v12 offset:4096
  s_waitcnt lgkmcnt(3)
  v_mfma_f32_32x32x16_bf16 v[192:207], v[68:71], v[212:215], v[192:207]
  buffer_load_dwordx4 v[36:39], v2, s[24:27], s68 offen offset:1024 sc1
  ds_read_b128 v[212:215], v12 offset:5120
  s_waitcnt lgkmcnt(3)
  v_mfma_f32_32x32x16_bf16 v[192:207], v[72:75], v[216:219], v[192:207]
  buffer_load_dwordx4 v[40:43], v2, s[24:27], s68 offen offset:2048 sc1
  ds_read_b128 v[216:219], v12 offset:16384
  s_waitcnt lgkmcnt(3)
  v_mfma_f32_32x32x16_bf16 v[192:207], v[76:79], v[220:223], v[192:207]
  buffer_load_dwordx4 v[44:47], v2, s[24:27], s68 offen offset:3072 sc1
  ds_read_b128 v[220:223], v12 offset:17408
  s_waitcnt lgkmcnt(3)
  v_mfma_f32_32x32x16_bf16 v[192:207], v[80:83], v[208:211], v[192:207]
  ds_read_b128 v[208:211], v12 offset:28672
  s_waitcnt lgkmcnt(3)
  v_mfma_f32_32x32x16_bf16 v[192:207], v[84:87], v[212:215], v[192:207]
  ds_read_b128 v[212:215], v12 offset:29696
  s_waitcnt lgkmcnt(3)
  v_mfma_f32_32x32x16_bf16 v[192:207], v[88:91], v[216:219], v[192:207]
  ds_read_b128 v[216:219], v12 offset:40960
  s_waitcnt lgkmcnt(3)
  v_mfma_f32_32x32x16_bf16 v[192:207], v[92:95], v[220:223], v[192:207]
  ds_read_b128 v[220:223], v12 offset:41984
  s_waitcnt lgkmcnt(3)
  v_mfma_f32_32x32x16_bf16 v[192:207], v[96:99], v[208:211], v[192:207]
  ds_read_b128 v[208:211], v12 offset:6144
  s_waitcnt lgkmcnt(3)
  v_mfma_f32_32x32x16_bf16 v[192:207], v[100:103], v[212:215], v[192:207]
  ds_read_b128 v[212:215], v12 offset:7168
  s_waitcnt lgkmcnt(3)
  v_mfma_f32_32x32x16_bf16 v[192:207], v[104:107], v[216:219], v[192:207]
  ds_read_b128 v[216:219], v12 offset:18432
  s_waitcnt lgkmcnt(3)
  v_mfma_f32_32x32x16_bf16 v[192:207], v[108:111], v[220:223], v[192:207]
  ds_read_b128 v[220:223], v12 offset:19456
  s_waitcnt lgkmcnt(3)
  v_mfma_f32_32x32x16_bf16 v[192:207], v[112:115], v[208:211], v[192:207]
  ds_read_b128 v[208:211], v12 offset:30720
  s_waitcnt lgkmcnt(3)
  v_mfma_f32_32x32x16_bf16 v[192:207], v[116:119], v[212:215], v[192:207]
  ds_read_b128 v[212:215], v12 offset:31744
  s_waitcnt lgkmcnt(3)
  v_mfma_f32_32x32x16_bf16 v[192:207], v[120:123], v[216:219], v[192:207]
  ds_read_b128 v[216:219], v12 offset:43008
  s_waitcnt lgkmcnt(3)
  v_mfma_f32_32x32x16_bf16 v[192:207], v[124:127], v[220:223], v[192:207]
  ds_read_b128 v[220:223], v12 offset:44032
  s_waitcnt lgkmcnt(3)
  v_mfma_f32_32x32x16_bf16 v[192:207], v[128:131], v[208:211], v[192:207]
  s_waitcnt lgkmcnt(2)
  v_mfma_f32_32x32x16_bf16 v[192:207], v[132:135], v[212:215], v[192:207]
  s_waitcnt lgkmcnt(1)
  v_mfma_f32_32x32x16_bf16 v[192:207], v[136:139], v[216:219], v[192:207]
  s_waitcnt lgkmcnt(0)
  v_mfma_f32_32x32x16_bf16 v[192:207], v[140:143], v[220:223], v[192:207]
  v_lshlrev_b32 v128, 16, v184
  v_and_b32 v129, 0xffff0000, v184
  v_lshlrev_b32 v130, 16, v185
  v_and_b32 v131, 0xffff0000, v185
  v_lshlrev_b32 v132, 16, v186
  v_and_b32 v133, 0xffff0000, v186
  v_lshlrev_b32 v134, 16, v187
  v_and_b32 v135, 0xffff0000, v187
  s_nop 3
  v_pk_fma_f32 v[160:161], v[192:193], v[144:145], v[160:161]
  v_pk_fma_f32 v[162:163], v[194:195], v[146:147], v[162:163]
  v_pk_fma_f32 v[164:165], v[196:197], v[148:149], v[164:165]
  v_pk_fma_f32 v[166:167], v[198:199], v[150:151], v[166:167]
  v_pk_fma_f32 v[168:169], v[200:201], v[152:153], v[168:169]
  v_pk_fma_f32 v[170:171], v[202:203], v[154:155], v[170:171]
  v_pk_fma_f32 v[172:173], v[204:205], v[156:157], v[172:173]
  v_pk_fma_f32 v[174:175], v[206:207], v[158:159], v[174:175]
  v_pk_add_f32 v[112:113], v[160:161], v[162:163]
  v_pk_mul_f32 v[114:115], v[160:161], v[160:161]
  v_pk_fma_f32 v[114:115], v[162:163], v[162:163], v[114:115]
  v_pk_add_f32 v[112:113], v[112:113], v[164:165]
  v_pk_fma_f32 v[114:115], v[164:165], v[164:165], v[114:115]
  v_pk_add_f32 v[112:113], v[112:113], v[166:167]
  v_pk_fma_f32 v[114:115], v[166:167], v[166:167], v[114:115]
  v_pk_add_f32 v[112:113], v[112:113], v[168:169]
  v_pk_fma_f32 v[114:115], v[168:169], v[168:169], v[114:115]
  v_pk_add_f32 v[112:113], v[112:113], v[170:171]
  v_pk_fma_f32 v[114:115], v[170:171], v[170:171], v[114:115]
  v_pk_add_f32 v[112:113], v[112:113], v[172:173]
  v_pk_fma_f32 v[114:115], v[172:173], v[172:173], v[114:115]
  v_pk_add_f32 v[112:113], v[112:113], v[174:175]
  v_pk_fma_f32 v[114:115], v[174:175], v[174:175], v[114:115]
  v_add_f32 v112, v112, v113
  v_add_f32 v114, v114, v115
  v_lshlrev_b32 v136, 16, v188
  v_and_b32 v137, 0xffff0000, v188
  v_permlane32_swap_b32 v112, v114
  v_add_f32 v112, v112, v114
  ds_write_b32 v8, v112
  v_lshlrev_b32 v138, 16, v189
  v_and_b32 v139, 0xffff0000, v189
  v_lshlrev_b32 v140, 16, v190
  v_and_b32 v141, 0xffff0000, v190
  v_lshlrev_b32 v142, 16, v191
  v_and_b32 v143, 0xffff0000, v191
  s_waitcnt lgkmcnt(0)
  s_barrier
  ds_read_b32 v116, v9 offset:0
  ds_read_b32 v117, v9 offset:256
  ds_read_b32 v118, v9 offset:512
  ds_read_b32 v119, v9 offset:768
  v_cvt_pk_bf16_f32 v144, v160, v161
  v_cvt_pk_bf16_f32 v145, v162, v163
  v_cvt_pk_bf16_f32 v146, v164, v165
  v_cvt_pk_bf16_f32 v147, v166, v167
  v_cvt_pk_bf16_f32 v148, v168, v169
  v_cvt_pk_bf16_f32 v149, v170, v171
  v_cvt_pk_bf16_f32 v150, v172, v173
  v_cvt_pk_bf16_f32 v151, v174, v175
  v_mov_b32 v113, v3
  s_waitcnt lgkmcnt(2)
  v_add_f32 v116, v116, v117
  s_waitcnt lgkmcnt(0)
  v_add_f32 v118, v118, v119
  v_add_f32 v112, v116, v118
  s_cmp_eq_u32 s61, 0
  s_cbranch_scc1 Lnl_78
  buffer_store_dwordx2 v[112:113], v15, s[24:27], s11 offen
Lnle_79:
  v_pk_add_f32 v[128:129], v[128:129], 1.0 op_sel_hi:[1,0]
  v_pk_add_f32 v[130:131], v[130:131], 1.0 op_sel_hi:[1,0]
  v_pk_add_f32 v[132:133], v[132:133], 1.0 op_sel_hi:[1,0]
  v_pk_add_f32 v[134:135], v[134:135], 1.0 op_sel_hi:[1,0]
  v_pk_add_f32 v[136:137], v[136:137], 1.0 op_sel_hi:[1,0]
  v_pk_add_f32 v[138:139], v[138:139], 1.0 op_sel_hi:[1,0]
  v_pk_add_f32 v[140:141], v[140:141], 1.0 op_sel_hi:[1,0]
  v_pk_add_f32 v[142:143], v[142:143], 1.0 op_sel_hi:[1,0]
  v_lshlrev_b32 v208, 16, v176
  v_and_b32 v209, 0xffff0000, v176
  v_lshlrev_b32 v210, 16, v177
  v_and_b32 v211, 0xffff0000, v177
  v_lshlrev_b32 v212, 16, v178
  v_and_b32 v213, 0xffff0000, v178
  v_lshlrev_b32 v214, 16, v179
  v_and_b32 v215, 0xffff0000, v179
  v_lshlrev_b32 v216, 16, v180
  v_and_b32 v217, 0xffff0000, v180
  v_lshlrev_b32 v218, 16, v181
  v_and_b32 v219, 0xffff0000, v181
  v_lshlrev_b32 v220, 16, v182
  v_and_b32 v221, 0xffff0000, v182
  v_lshlrev_b32 v222, 16, v183
  v_and_b32 v223, 0xffff0000, v183
  s_lshl_b32 s65, s54, 15
  s_add_u32 s65, s65, 6291456
  s_add_u32 s63, s8, s65
  s_add_u32 s64, s9, s65
  s_add_u32 s66, s62, 36864
Lpoll_80:
  buffer_load_dwordx2 v[120:121], v15, s[24:27], s10 offen offset:0 sc1
  buffer_load_dwordx2 v[122:123], v15, s[24:27], s10 offen offset:512 sc1
  buffer_load_dwordx2 v[124:125], v15, s[24:27], s10 offen offset:1024 sc1
  buffer_load_dwordx2 v[126:127], v15, s[24:27], s10 offen offset:1536 sc1
  s_sub_u32 s59, s59, 1
  s_cmp_lt_i32 s59, 0
  s_cbranch_scc1 Lpdone_81
  s_waitcnt vmcnt(3)
  v_xor_b32 v6, v3, v121
  s_waitcnt vmcnt(2)
  v_bitop3_b32 v6, v6, v123, v3 bitop3:0xf6
  s_waitcnt vmcnt(1)
  v_bitop3_b32 v6, v6, v125, v3 bitop3:0xf6
  s_waitcnt vmcnt(0)
  v_bitop3_b32 v6, v6, v127, v3 bitop3:0xf6
  v_cmp_ne_u32 vcc, 0, v6
  s_cbranch_vccnz Lpoll_80
Lpdone_81:
  s_waitcnt vmcnt(2)
  v_add_f32 v120, v120, v122
  s_waitcnt vmcnt(0)
  v_add_f32 v124, v124, v126
  v_add_f32 v120, v120, v124
  v_mul_f32 v120, 0x3b124925, v120
  v_mov_b32 v121, v120
  s_nop 1
  v_permlane32_swap_b32 v120, v121
  v_fma_f32 v121, -v120, v120, v121
  v_max_f32 v121, 0, v121
  v_add_f32 v121, 0x3727c5ac, v121
  v_rsq_f32 v122, v121
  s_nop 0
  v_mul_f32 v123, -v120, v122
  v_pk_fma_f32 v[160:161], v[160:161], v[122:123], v[122:123] op_sel:[0,0,1] op_sel_hi:[1,0,1]
  v_pk_fma_f32 v[162:163], v[162:163], v[122:123], v[122:123] op_sel:[0,0,1] op_sel_hi:[1,0,1]
  v_pk_fma_f32 v[164:165], v[164:165], v[122:123], v[122:123] op_sel:[0,0,1] op_sel_hi:[1,0,1]
  v_pk_fma_f32 v[166:167], v[166:167], v[122:123], v[122:123] op_sel:[0,0,1] op_sel_hi:[1,0,1]
  v_pk_fma_f32 v[168:169], v[168:169], v[122:123], v[122:123] op_sel:[0,0,1] op_sel_hi:[1,0,1]
  v_pk_fma_f32 v[170:171], v[170:171], v[122:123], v[122:123] op_sel:[0,0,1] op_sel_hi:[1,0,1]
  v_pk_fma_f32 v[172:173], v[172:173], v[122:123], v[122:123] op_sel:[0,0,1] op_sel_hi:[1,0,1]
  v_pk_fma_f32 v[174:175], v[174:175], v[122:123], v[122:123] op_sel:[0,0,1] op_sel_hi:[1,0,1]
  v_pk_fma_f32 v[160:161], v[160:161], v[128:129], v[208:209]
  v_pk_fma_f32 v[162:163], v[162:163], v[130:131], v[210:211]
  v_pk_fma_f32 v[164:165], v[164:165], v[132:133], v[212:213]
  v_pk_fma_f32 v[166:167], v[166:167], v[134:135], v[214:215]
  v_pk_fma_f32 v[168:169], v[168:169], v[136:137], v[216:217]
  v_pk_fma_f32 v[170:171], v[170:171], v[138:139], v[218:219]
  v_pk_fma_f32 v[172:173], v[172:173], v[140:141], v[220:221]
  v_pk_fma_f32 v[174:175], v[174:175], v[142:143], v[222:223]
  v_cvt_pk_bf16_f32 v192, v160, v161
  v_cvt_pk_bf16_f32 v193, v162, v163
  v_cvt_pk_bf16_f32 v194, v164, v165
  v_cvt_pk_bf16_f32 v195, v166, v167
  v_cvt_pk_bf16_f32 v196, v168, v169
  v_cvt_pk_bf16_f32 v197, v170, v171
  v_cvt_pk_bf16_f32 v198, v172, v173
  v_cvt_pk_bf16_f32 v199, v174, v175
  s_cmp_eq_u32 s61, 0
  s_cbranch_scc1 Lnl_82
  buffer_store_dwordx4 v[192:195], v2, s[24:27], s63 offen
  buffer_store_dwordx4 v[196:199], v2, s[24:27], s64 offen
Lnle_83:
  s_barrier
  s_waitcnt vmcnt(0)
  s_mov_b64 exec, 1
  s_cmp_eq_u32 s61, 0
  s_cbranch_scc1 Lnl_84
  buffer_store_dword v3, off, s[24:27], s66
Lnle_85:
  s_mov_b64 exec, -1
  s_setprio 0
  s_mul_i32 s65, s54, 28672
  s_add_u32 s65, s65, 8388608
  s_add_u32 s63, s8, s65
  s_add_u32 s64, s9, s65
  s_lshl_b32 s37, s56, 1
  s_add_u32 s37, s37, s45
  s_lshl_b32 s37, s37, 2
  s_add_u32 s37, s37, s52
  s_mul_i32 s66, s52, 28672
  s_add_u32 s66, s66, 10485760
  s_xor_b32 s65, s37, 0
  s_lshr_b32 s74, s65, 1
  s_mul_i32 s74, s74, 114688
  s_and_b32 s65, s65, 1
  s_lshl_b32 s65, s65, 8
  s_add_u32 s65, s65, s66
  s_add_u32 s74, s74, s65
  s_xor_b32 s65, s37, 1
  s_lshr_b32 s75, s65, 1
  s_mul_i32 s75, s75, 114688
  s_and_b32 s65, s65, 1
  s_lshl_b32 s65, s65, 8
  s_add_u32 s65, s65, s66
  s_add_u32 s75, s75, s65
  s_xor_b32 s65, s37, 2
  s_lshr_b32 s76, s65, 1
  s_mul_i32 s76, s76, 114688
  s_and_b32 s65, s65, 1
  s_lshl_b32 s65, s65, 8
  s_add_u32 s65, s65, s66
  s_add_u32 s76, s76, s65
  s_xor_b32 s65, s37, 3
  s_lshr_b32 s77, s65, 1
  s_mul_i32 s77, s77, 114688
  s_and_b32 s65, s65, 1
  s_lshl_b32 s65, s65, 8
  s_add_u32 s65, s65, s66
  s_add_u32 s77, s77, s65
  s_lshl_b32 s36, s56, 8
  s_add_u32 s36, s36, 40960
  s_lshl_b32 s65, s52, 6
  s_lshl_b32 s66, s45, 3
  s_add_u32 s65, s65, s66
  s_add_u32 s38, s65, s36
  v_and_b32 v6, 3, v1
  v_lshl_add_u32 v6, v6, 4, s65
  v_and_b32 v7, 4, v1
  v_add_u32 v13, v6, v7
  s_lshl_b32 s66, s45, 7
  v_and_b32 v6, 7, v1
  v_lshl_add_u32 v15, v6, 4, s66
  s_barrier
  buffer_store_dwordx4 v[144:147], v2, s[24:27], s63 offen sc1
  buffer_store_dwordx4 v[148:151], v2, s[24:27], s64 offen sc1
  s_add_u32 m0, s44, 114688
  s_add_u32 s67, s41, 458752
  buffer_load_dwordx4 v2, s[24:27], s67 offen offset:0 sc1 lds
  buffer_load_dwordx4 v2, s[24:27], s67 offen offset:1024 sc1 lds
  buffer_load_dwordx4 v2, s[24:27], s67 offen offset:2048 sc1 lds
  buffer_load_dwordx4 v2, s[24:27], s67 offen offset:3072 sc1 lds
  s_add_u32 m0, s44, 118784
  s_add_u32 s67, s41, 462848
  buffer_load_dwordx4 v2, s[24:27], s67 offen offset:0 sc1 lds
  buffer_load_dwordx4 v2, s[24:27], s67 offen offset:1024 sc1 lds
  buffer_load_dwordx4 v2, s[24:27], s67 offen offset:2048 sc1 lds
  s_add_u32 s68, s40, 16384
  buffer_load_dwordx4 v[48:51], v2, s[24:27], s68 offen offset:0 sc1
  buffer_load_dwordx4 v[52:55], v2, s[24:27], s68 offen offset:1024 sc1
  buffer_load_dwordx4 v[56:59], v2, s[24:27], s68 offen offset:2048 sc1
  buffer_load_dwordx4 v[60:63], v2, s[24:27], s68 offen offset:3072 sc1
  s_add_u32 s68, s40, 20480
  buffer_load_dwordx4 v[64:67], v2, s[24:27], s68 offen offset:0 sc1
  buffer_load_dwordx4 v[68:71], v2, s[24:27], s68 offen offset:1024 sc1
  buffer_load_dwordx4 v[72:75], v2, s[24:27], s68 offen offset:2048 sc1
  buffer_load_dwordx4 v[76:79], v2, s[24:27], s68 offen offset:3072 sc1
  s_add_u32 s68, s40, 24576
  buffer_load_dwordx4 v[80:83], v2, s[24:27], s68 offen offset:0 sc1
  buffer_load_dwordx4 v[84:87], v2, s[24:27], s68 offen offset:1024 sc1
  buffer_load_dwordx4 v[88:91], v2, s[24:27], s68 offen offset:2048 sc1
  buffer_load_dwordx4 v[92:95], v2, s[24:27], s68 offen offset:3072 sc1
  s_waitcnt vmcnt(12)
  s_barrier
  s_add_u32 m0, s44, 0
  s_add_u32 s67, s41, 573440
  buffer_load_dwordx4 v2, s[24:27], s67 offen offset:0 sc1 lds
  buffer_load_dwordx4 v2, s[24:27], s67 offen offset:1024 sc1 lds
  buffer_load_dwordx4 v2, s[24:27], s67 offen offset:2048 sc1 lds
  buffer_load_dwordx4 v2, s[24:27], s67 offen offset:3072 sc1 lds
  s_add_u32 m0, s44, 4096
  s_add_u32 s67, s41, 577536
  buffer_load_dwordx4 v2, s[24:27], s67 offen offset:0 sc1 lds
  buffer_load_dwordx4 v2, s[24:27], s67 offen offset:1024 sc1 lds
  buffer_load_dwordx4 v2, s[24:27], s67 offen offset:2048 sc1 lds
  s_add_u32 m0, s44, 28672
  s_add_u32 s67, s41, 688128
  buffer_load_dwordx4 v2, s[24:27], s67 offen offset:0 sc1 lds
  buffer_load_dwordx4 v2, s[24:27], s67 offen offset:1024 sc1 lds
  buffer_load_dwordx4 v2, s[24:27], s67 offen offset:2048 sc1 lds
  buffer_load_dwordx4 v2, s[24:27], s67 offen offset:3072 sc1 lds
  s_add_u32 m0, s44, 32768
  s_add_u32 s67, s41, 692224
  buffer_load_dwordx4 v2, s[24:27], s67 offen offset:0 sc1 lds
  buffer_load_dwordx4 v2, s[24:27], s67 offen offset:1024 sc1 lds
  buffer_load_dwordx4 v2, s[24:27], s67 offen offset:2048 sc1 lds
  s_add_u32 s68, s40, 28672
  buffer_load_dwordx4 v[96:99], v2, s[24:27], s68 offen offset:0 sc1
  buffer_load_dwordx4 v[100:103], v2, s[24:27], s68 offen offset:1024 sc1
  buffer_load_dwordx4 v[104:107], v2, s[24:27], s68 offen offset:2048 sc1
  buffer_load_dwordx4 v[108:111], v2, s[24:27], s68 offen offset:3072 sc1
  s_waitcnt vmcnt(4)
  s_barrier
  s_cmp_ge_u32 s57, 14
  s_cbranch_scc1 Llfin
  v_add_u32 v14, 1, v3
  v_mov_b32 v8, v13
  buffer_load_dword v7, v8, s[24:27], s36 offen sc1
  s_add_u32 s68, s40, 32768
  s_mul_i32 s67, s52, 4096
  s_add_u32 m0, s67, 57344
  s_nop 0
  buffer_load_dwordx4 v2, s[24:27], s68 offen offset:0 sc1 lds
  buffer_load_dwordx4 v2, s[24:27], s68 offen offset:1024 sc1 lds
  buffer_load_dwordx4 v2, s[24:27], s68 offen offset:2048 sc1 lds
  buffer_load_dwordx4 v2, s[24:27], s68 offen offset:3072 sc1 lds
  s_add_u32 s68, s40, 36864
  s_mul_i32 s67, s52, 4096
  s_add_u32 m0, s67, 143360
  s_nop 0
  buffer_load_dwordx4 v2, s[24:27], s68 offen offset:0 sc1 lds
  buffer_load_dwordx4 v2, s[24:27], s68 offen offset:1024 sc1 lds
  buffer_load_dwordx4 v2, s[24:27], s68 offen offset:2048 sc1 lds
  buffer_load_dwordx4 v2, s[24:27], s68 offen offset:3072 sc1 lds
  s_add_u32 s68, s40, 40960
  s_mul_i32 s67, s52, 3072
  s_add_u32 m0, s67, 73728
  s_nop 0
  buffer_load_dwordx4 v2, s[24:27], s68 offen offset:0 sc1 lds
  buffer_load_dwordx4 v2, s[24:27], s68 offen offset:1024 sc1 lds
  buffer_load_dwordx4 v2, s[24:27], s68 offen offset:2048 sc1 lds
  s_mul_i32 s67, s52, 1024
  s_add_u32 m0, s67, 156672
  s_nop 0
  buffer_load_dwordx4 v2, s[24:27], s68 offen offset:3072 sc1 lds
  s_waitcnt vmcnt(12)
  v_sub_u32 v7, v7, v14
  v_cmp_lt_u32 vcc, 4, v7
  s_cbranch_vccz Lhok_86
Lpoll_87:
  buffer_load_dword v7, v8, s[24:27], s36 offen sc1
  s_sub_u32 s59, s59, 1
  s_cmp_lt_i32 s59, 0
  s_cbranch_scc1 Lpdone_88
  s_waitcnt vmcnt(0)
  v_sub_u32 v7, v7, v14
  v_cmp_lt_u32 vcc, 4, v7
  s_cbranch_vccnz Lpoll_87
Lpdone_88:
Lhok_86:
  buffer_load_dwordx4 v[180:183], v10, s[24:27], s75 offen offset:0 sc1
  buffer_load_dwordx4 v[184:187], v10, s[24:27], s76 offen offset:0 sc1
  buffer_load_dwordx4 v[188:191], v10, s[24:27], s77 offen offset:0 sc1
  buffer_load_dwordx4 v[176:179], v10, s[24:27], s74 offen offset:0 sc1
  s_addk_i32 s75, 4096
  buffer_load_dwordx4 v[196:199], v10, s[24:27], s75 offen offset:0 sc1
  s_addk_i32 s76, 4096
  buffer_load_dwordx4 v[200:203], v10, s[24:27], s76 offen offset:0 sc1
  s_addk_i32 s77, 4096
  buffer_load_dwordx4 v[204:207], v10, s[24:27], s77 offen offset:0 sc1
  s_addk_i32 s74, 4096
  buffer_load_dwordx4 v[192:195], v10, s[24:27], s74 offen offset:0 sc1
  s_addk_i32 s75, 4096
  buffer_load_dwordx4 v[212:215], v10, s[24:27], s75 offen offset:0 sc1
  v_add_u32 v14, 2, v3
  v_mov_b32 v8, v13
  buffer_load_dword v7, v8, s[24:27], s36 offen sc1
  s_addk_i32 s76, 4096
  buffer_load_dwordx4 v[216:219], v10, s[24:27], s76 offen offset:0 sc1
  s_addk_i32 s77, 4096
  buffer_load_dwordx4 v[220:223], v10, s[24:27], s77 offen offset:0 sc1
  s_addk_i32 s74, 4096
  buffer_load_dwordx4 v[208:211], v10, s[24:27], s74 offen offset:0 sc1
  s_waitcnt vmcnt(12)
  v_mfma_f32_16x16x32_bf16 v[128:131], v[224:227], v[180:183], 0
  v_mfma_f32_16x16x32_bf16 v[132:135], v[228:231], v[180:183], 0
  v_mfma_f32_16x16x32_bf16 v[136:139], v[232:235], v[180:183], 0
  v_mfma_f32_16x16x32_bf16 v[140:143], v[236:239], v[180:183], 0
  s_addk_i32 s75, 4096
  buffer_load_dwordx4 v[180:183], v10, s[24:27], s75 offen offset:0 sc1
  s_waitcnt vmcnt(12)
  v_mfma_f32_16x16x32_bf16 v[144:147], v[224:227], v[184:187], 0
  v_mfma_f32_16x16x32_bf16 v[148:151], v[228:231], v[184:187], 0
  v_mfma_f32_16x16x32_bf16 v[152:155], v[232:235], v[184:187], 0
  v_mfma_f32_16x16x32_bf16 v[156:159], v[236:239], v[184:187], 0
  s_addk_i32 s76, 4096
  buffer_load_dwordx4 v[184:187], v10, s[24:27], s76 offen offset:0 sc1
  s_waitcnt vmcnt(12)
  v_mfma_f32_16x16x32_bf16 v[160:163], v[224:227], v[188:191], 0
  v_mfma_f32_16x16x32_bf16 v[164:167], v[228:231], v[188:191], 0
  v_mfma_f32_16x16x32_bf16 v[168:171], v[232:235], v[188:191], 0
  v_mfma_f32_16x16x32_bf16 v[172:175], v[236:239], v[188:191], 0
  s_addk_i32 s77, 4096
  buffer_load_dwordx4 v[188:191], v10, s[24:27], s77 offen offset:0 sc1
  s_waitcnt vmcnt(12)
  v_mfma_f32_16x16x32_bf16 v[112:115], v[224:227], v[176:179], 0
  v_mfma_f32_16x16x32_bf16 v[116:119], v[228:231], v[176:179], 0
  v_mfma_f32_16x16x32_bf16 v[120:123], v[232:235], v[176:179], 0
  v_mfma_f32_16x16x32_bf16 v[124:127], v[236:239], v[176:179], 0
  s_addk_i32 s74, 4096
  buffer_load_dwordx4 v[176:179], v10, s[24:27], s74 offen offset:0 sc1
  s_waitcnt vmcnt(12)
  v_mfma_f32_16x16x32_bf16 v[128:131], v[16:19], v[196:199], v[128:131]
  v_mfma_f32_16x16x32_bf16 v[132:135], v[20:23], v[196:199], v[132:135]
  v_mfma_f32_16x16x32_bf16 v[136:139], v[24:27], v[196:199], v[136:139]
  v_mfma_f32_16x16x32_bf16 v[140:143], v[28:31], v[196:199], v[140:143]
  s_waitcnt vmcnt(7)
  v_sub_u32 v7, v7, v14
  v_cmp_lt_u32 vcc, 4, v7
  s_cbranch_vccz Lhok_89
Lpoll_90:
  buffer_load_dword v7, v8, s[24:27], s36 offen sc1
  s_sub_u32 s59, s59, 1
  s_cmp_lt_i32 s59, 0
  s_cbranch_scc1 Lpdone_91
  s_waitcnt vmcnt(0)
  v_sub_u32 v7, v7, v14
  v_cmp_lt_u32 vcc, 4, v7
  s_cbranch_vccnz Lpoll_90
Lpdone_91:
Lhok_89:
  s_addk_i32 s75, -12288
  buffer_load_dwordx4 v[196:199], v10, s[24:27], s75 offen offset:2048 sc1
  v_mfma_f32_16x16x32_bf16 v[144:147], v[16:19], v[200:203], v[144:147]
  s_add_u32 s68, s40, 45056
  buffer_load_dwordx4 v[224:227], v2, s[24:27], s68 offen offset:0 sc1
  v_mfma_f32_16x16x32_bf16 v[148:151], v[20:23], v[200:203], v[148:151]
  buffer_load_dwordx4 v[228:231], v2, s[24:27], s68 offen offset:1024 sc1
  v_mfma_f32_16x16x32_bf16 v[152:155], v[24:27], v[200:203], v[152:155]
  buffer_load_dwordx4 v[232:235], v2, s[24:27], s68 offen offset:2048 sc1
  v_mfma_f32_16x16x32_bf16 v[156:159], v[28:31], v[200:203], v[156:159]
  buffer_load_dwordx4 v[236:239], v2, s[24:27], s68 offen offset:3072 sc1
  s_addk_i32 s76, -12288
  buffer_load_dwordx4 v[200:203], v10, s[24:27], s76 offen offset:2048 sc1
  v_mfma_f32_16x16x32_bf16 v[160:163], v[16:19], v[204:207], v[160:163]
  v_mfma_f32_16x16x32_bf16 v[164:167], v[20:23], v[204:207], v[164:167]
  v_mfma_f32_16x16x32_bf16 v[168:171], v[24:27], v[204:207], v[168:171]
  v_mfma_f32_16x16x32_bf16 v[172:175], v[28:31], v[204:207], v[172:175]
  s_addk_i32 s77, -12288
  buffer_load_dwordx4 v[204:207], v10, s[24:27], s77 offen offset:2048 sc1
  v_mfma_f32_16x16x32_bf16 v[112:115], v[16:19], v[192:195], v[112:115]
  v_mfma_f32_16x16x32_bf16 v[116:119], v[20:23], v[192:195], v[116:119]
  v_mfma_f32_16x16x32_bf16 v[120:123], v[24:27], v[192:195], v[120:123]
  v_mfma_f32_16x16x32_bf16 v[124:127], v[28:31], v[192:195], v[124:127]
  s_addk_i32 s74, -12288
  buffer_load_dwordx4 v[192:195], v10, s[24:27], s74 offen offset:2048 sc1
  v_mfma_f32_16x16x32_bf16 v[128:131], v[48:51], v[212:215], v[128:131]
  v_mfma_f32_16x16x32_bf16 v[132:135], v[52:55], v[212:215], v[132:135]
  v_mfma_f32_16x16x32_bf16 v[136:139], v[56:59], v[212:215], v[136:139]
  v_mfma_f32_16x16x32_bf16 v[140:143], v[60:63], v[212:215], v[140:143]
  s_addk_i32 s75, 4096
  buffer_load_dwordx4 v[212:215], v10, s[24:27], s75 offen offset:2048 sc1
  s_waitcnt vmcnt(15)
  v_mfma_f32_16x16x32_bf16 v[144:147], v[48:51], v[216:219], v[144:147]
  s_add_u32 s68, s40, 49152
  buffer_load_dwordx4 v[16:19], v2, s[24:27], s68 offen offset:0 sc1
  v_mfma_f32_16x16x32_bf16 v[148:151], v[52:55], v[216:219], v[148:151]
  buffer_load_dwordx4 v[20:23], v2, s[24:27], s68 offen offset:1024 sc1
  v_mfma_f32_16x16x32_bf16 v[152:155], v[56:59], v[216:219], v[152:155]
  buffer_load_dwordx4 v[24:27], v2, s[24:27], s68 offen offset:2048 sc1
  v_mfma_f32_16x16x32_bf16 v[156:159], v[60:63], v[216:219], v[156:159]
  buffer_load_dwordx4 v[28:31], v2, s[24:27], s68 offen offset:3072 sc1
  s_addk_i32 s76, 4096
  buffer_load_dwordx4 v[216:219], v10, s[24:27], s76 offen offset:2048 sc1
  s_waitcnt vmcnt(19)
  v_mfma_f32_16x16x32_bf16 v[160:163], v[48:51], v[220:223], v[160:163]
  v_mfma_f32_16x16x32_bf16 v[164:167], v[52:55], v[220:223], v[164:167]
  v_mfma_f32_16x16x32_bf16 v[168:171], v[56:59], v[220:223], v[168:171]
  v_mfma_f32_16x16x32_bf16 v[172:175], v[60:63], v[220:223], v[172:175]
  s_addk_i32 s77, 4096
  buffer_load_dwordx4 v[220:223], v10, s[24:27], s77 offen offset:2048 sc1
  s_waitcnt vmcnt(19)
  v_mfma_f32_16x16x32_bf16 v[112:115], v[48:51], v[208:211], v[112:115]
  v_mfma_f32_16x16x32_bf16 v[116:119], v[52:55], v[208:211], v[116:119]
  v_mfma_f32_16x16x32_bf16 v[120:123], v[56:59], v[208:211], v[120:123]
  v_mfma_f32_16x16x32_bf16 v[124:127], v[60:63], v[208:211], v[124:127]
  s_addk_i32 s74, 4096
  buffer_load_dwordx4 v[208:211], v10, s[24:27], s74 offen offset:2048 sc1
  s_waitcnt vmcnt(19)
  v_mfma_f32_16x16x32_bf16 v[128:131], v[80:83], v[180:183], v[128:131]
  v_mfma_f32_16x16x32_bf16 v[132:135], v[84:87], v[180:183], v[132:135]
  v_mfma_f32_16x16x32_bf16 v[136:139], v[88:91], v[180:183], v[136:139]
  v_mfma_f32_16x16x32_bf16 v[140:143], v[92:95], v[180:183], v[140:143]
  s_addk_i32 s75, 4096
  buffer_load_dwordx4 v[180:183], v10, s[24:27], s75 offen offset:2048 sc1
  v_add_u32 v14, 4, v3
  v_mov_b32 v8, v13
  s_mov_b64 exec, 0xff00
  v_mov_b32 v8, v15
  v_add_u32 v14, 1, v3
  s_mov_b64 exec, -1
  buffer_load_dword v7, v8, s[24:27], s36 offen sc1
  s_waitcnt vmcnt(20)
  v_mfma_f32_16x16x32_bf16 v[144:147], v[80:83], v[184:187], v[144:147]
  s_add_u32 s68, s40, 53248
  buffer_load_dwordx4 v[48:51], v2, s[24:27], s68 offen offset:0 sc1
  v_mfma_f32_16x16x32_bf16 v[148:151], v[84:87], v[184:187], v[148:151]
  buffer_load_dwordx4 v[52:55], v2, s[24:27], s68 offen offset:1024 sc1
  v_mfma_f32_16x16x32_bf16 v[152:155], v[88:91], v[184:187], v[152:155]
  buffer_load_dwordx4 v[56:59], v2, s[24:27], s68 offen offset:2048 sc1
  v_mfma_f32_16x16x32_bf16 v[156:159], v[92:95], v[184:187], v[156:159]
  buffer_load_dwordx4 v[60:63], v2, s[24:27], s68 offen offset:3072 sc1
  s_addk_i32 s76, 4096
  buffer_load_dwordx4 v[184:187], v10, s[24:27], s76 offen offset:2048 sc1
  s_waitcnt vmcnt(24)
  v_mfma_f32_16x16x32_bf16 v[160:163], v[80:83], v[188:191], v[160:163]
  v_mfma_f32_16x16x32_bf16 v[164:167], v[84:87], v[188:191], v[164:167]
  v_mfma_f32_16x16x32_bf16 v[168:171], v[88:91], v[188:191], v[168:171]
  v_mfma_f32_16x16x32_bf16 v[172:175], v[92:95], v[188:191], v[172:175]
  s_addk_i32 s77, 4096
  buffer_load_dwordx4 v[188:191], v10, s[24:27], s77 offen offset:2048 sc1
  s_waitcnt vmcnt(24)
  v_mfma_f32_16x16x32_bf16 v[112:115], v[80:83], v[176:179], v[112:115]
  v_mfma_f32_16x16x32_bf16 v[116:119], v[84:87], v[176:179], v[116:119]
  v_mfma_f32_16x16x32_bf16 v[120:123], v[88:91], v[176:179], v[120:123]
  v_mfma_f32_16x16x32_bf16 v[124:127], v[92:95], v[176:179], v[124:127]
  s_addk_i32 s74, 4096
  buffer_load_dwordx4 v[176:179], v10, s[24:27], s74 offen offset:2048 sc1
  s_waitcnt vmcnt(24)
  v_mfma_f32_16x16x32_bf16 v[128:131], v[240:243], v[196:199], v[128:131]
  v_mfma_f32_16x16x32_bf16 v[132:135], v[244:247], v[196:199], v[132:135]
  v_mfma_f32_16x16x32_bf16 v[136:139], v[248:251], v[196:199], v[136:139]
  v_mfma_f32_16x16x32_bf16 v[140:143], v[252:255], v[196:199], v[140:143]
  s_addk_i32 s75, 4096
  buffer_load_dwordx4 v[196:199], v10, s[24:27], s75 offen offset:2048 sc1
  s_waitcnt vmcnt(20)
  v_mfma_f32_16x16x32_bf16 v[144:147], v[240:243], v[200:203], v[144:147]
  s_mul_i32 s67, s52, 4096
  s_add_u32 s67, s67, 57344
  v_add_u32 v9, s67, v2
  ds_read_b128 v[80:83], v9 offset:0
  v_mfma_f32_16x16x32_bf16 v[148:151], v[244:247], v[200:203], v[148:151]
  ds_read_b128 v[84:87], v9 offset:1024
  v_mfma_f32_16x16x32_bf16 v[152:155], v[248:251], v[200:203], v[152:155]
  ds_read_b128 v[88:91], v9 offset:2048
  v_mfma_f32_16x16x32_bf16 v[156:159], v[252:255], v[200:203], v[156:159]
  ds_read_b128 v[92:95], v9 offset:3072
  s_addk_i32 s76, 4096
  buffer_load_dwordx4 v[200:203], v10, s[24:27], s76 offen offset:2048 sc1
  s_waitcnt vmcnt(20)
  v_mfma_f32_16x16x32_bf16 v[160:163], v[240:243], v[204:207], v[160:163]
  v_mfma_f32_16x16x32_bf16 v[164:167], v[244:247], v[204:207], v[164:167]
  v_mfma_f32_16x16x32_bf16 v[168:171], v[248:251], v[204:207], v[168:171]
  v_mfma_f32_16x16x32_bf16 v[172:175], v[252:255], v[204:207], v[172:175]
  s_addk_i32 s77, 4096
  buffer_load_dwordx4 v[204:207], v10, s[24:27], s77 offen offset:2048 sc1
  s_waitcnt vmcnt(20)
  v_mfma_f32_16x16x32_bf16 v[112:115], v[240:243], v[192:195], v[112:115]
  v_mfma_f32_16x16x32_bf16 v[116:119], v[244:247], v[192:195], v[116:119]
  v_mfma_f32_16x16x32_bf16 v[120:123], v[248:251], v[192:195], v[120:123]
  v_mfma_f32_16x16x32_bf16 v[124:127], v[252:255], v[192:195], v[124:127]
  s_addk_i32 s74, 4096
  buffer_load_dwordx4 v[192:195], v10, s[24:27], s74 offen offset:2048 sc1
  s_waitcnt vmcnt(20)
  v_mfma_f32_16x16x32_bf16 v[128:131], v[32:35], v[212:215], v[128:131]
  v_mfma_f32_16x16x32_bf16 v[132:135], v[36:39], v[212:215], v[132:135]
  v_mfma_f32_16x16x32_bf16 v[136:139], v[40:43], v[212:215], v[136:139]
  v_mfma_f32_16x16x32_bf16 v[140:143], v[44:47], v[212:215], v[140:143]
  s_waitcnt vmcnt(11)
  v_sub_u32 v7, v7, v14
  v_cmp_lt_u32 vcc, 4, v7
  s_cbranch_vccz Lhok_92
Lpoll_93:
  buffer_load_dword v7, v8, s[24:27], s36 offen sc1
  s_sub_u32 s59, s59, 1
  s_cmp_lt_i32 s59, 0
  s_cbranch_scc1 Lpdone_94
  s_waitcnt vmcnt(0)
  v_sub_u32 v7, v7, v14
  v_cmp_lt_u32 vcc, 4, v7
  s_cbranch_vccnz Lpoll_93
Lpdone_94:
Lhok_92:
  s_addk_i32 s75, 4096
  buffer_load_dwordx4 v[212:215], v10, s[24:27], s75 offen offset:0 sc1
  v_mfma_f32_16x16x32_bf16 v[144:147], v[32:35], v[216:219], v[144:147]
  s_mul_i32 s67, s52, 4096
  s_add_u32 s67, s67, 143360
  v_add_u32 v9, s67, v2
  ds_read_b128 v[240:243], v9 offset:0
  v_mfma_f32_16x16x32_bf16 v[148:151], v[36:39], v[216:219], v[148:151]
  ds_read_b128 v[244:247], v9 offset:1024
  v_mfma_f32_16x16x32_bf16 v[152:155], v[40:43], v[216:219], v[152:155]
  ds_read_b128 v[248:251], v9 offset:2048
  v_mfma_f32_16x16x32_bf16 v[156:159], v[44:47], v[216:219], v[156:159]
  ds_read_b128 v[252:255], v9 offset:3072
  s_addk_i32 s76, 4096
  buffer_load_dwordx4 v[216:219], v10, s[24:27], s76 offen offset:0 sc1
  v_mfma_f32_16x16x32_bf16 v[160:163], v[32:35], v[220:223], v[160:163]
  v_mfma_f32_16x16x32_bf16 v[164:167], v[36:39], v[220:223], v[164:167]
  v_mfma_f32_16x16x32_bf16 v[168:171], v[40:43], v[220:223], v[168:171]
  v_mfma_f32_16x16x32_bf16 v[172:175], v[44:47], v[220:223], v[172:175]
  s_addk_i32 s77, 4096
  buffer_load_dwordx4 v[220:223], v10, s[24:27], s77 offen offset:0 sc1
  v_mfma_f32_16x16x32_bf16 v[112:115], v[32:35], v[208:211], v[112:115]
  v_mfma_f32_16x16x32_bf16 v[116:119], v[36:39], v[208:211], v[116:119]
  v_mfma_f32_16x16x32_bf16 v[120:123], v[40:43], v[208:211], v[120:123]
  v_mfma_f32_16x16x32_bf16 v[124:127], v[44:47], v[208:211], v[124:127]
  s_addk_i32 s74, 4096
  buffer_load_dwordx4 v[208:211], v10, s[24:27], s74 offen offset:0 sc1
  v_mfma_f32_16x16x32_bf16 v[128:131], v[64:67], v[180:183], v[128:131]
  v_mfma_f32_16x16x32_bf16 v[132:135], v[68:71], v[180:183], v[132:135]
  v_mfma_f32_16x16x32_bf16 v[136:139], v[72:75], v[180:183], v[136:139]
  v_mfma_f32_16x16x32_bf16 v[140:143], v[76:79], v[180:183], v[140:143]
  buffer_load_dwordx4 v[180:183], v10, s[24:27], s75 offen offset:2048 sc1
  v_add_u32 v14, 5, v3
  v_mov_b32 v8, v13
  buffer_load_dword v7, v8, s[24:27], s36 offen sc1
  s_waitcnt vmcnt(12)
  v_mfma_f32_16x16x32_bf16 v[144:147], v[64:67], v[184:187], v[144:147]
  s_mul_i32 s67, s52, 3072
  s_add_u32 s67, s67, 73728
  v_add_u32 v9, s67, v2
  ds_read_b128 v[32:35], v9 offset:0
  v_mfma_f32_16x16x32_bf16 v[148:151], v[68:71], v[184:187], v[148:151]
  ds_read_b128 v[36:39], v9 offset:1024
  v_mfma_f32_16x16x32_bf16 v[152:155], v[72:75], v[184:187], v[152:155]
  ds_read_b128 v[40:43], v9 offset:2048
  v_mfma_f32_16x16x32_bf16 v[156:159], v[76:79], v[184:187], v[156:159]
  s_mul_i32 s67, s52, 1024
  s_add_u32 s67, s67, 156672
  v_add_u32 v9, s67, v2
  ds_read_b128 v[44:47], v9 offset:3072
  buffer_load_dwordx4 v[184:187], v10, s[24:27], s76 offen offset:2048 sc1
  s_waitcnt vmcnt(12)
  v_mfma_f32_16x16x32_bf16 v[160:163], v[64:67], v[188:191], v[160:163]
  v_mfma_f32_16x16x32_bf16 v[164:167], v[68:71], v[188:191], v[164:167]
  v_mfma_f32_16x16x32_bf16 v[168:171], v[72:75], v[188:191], v[168:171]
  v_mfma_f32_16x16x32_bf16 v[172:175], v[76:79], v[188:191], v[172:175]
  buffer_load_dwordx4 v[188:191], v10, s[24:27], s77 offen offset:2048 sc1
  s_waitcnt vmcnt(12)
  v_mfma_f32_16x16x32_bf16 v[112:115], v[64:67], v[176:179], v[112:115]
  v_mfma_f32_16x16x32_bf16 v[116:119], v[68:71], v[176:179], v[116:119]
  v_mfma_f32_16x16x32_bf16 v[120:123], v[72:75], v[176:179], v[120:123]
  v_mfma_f32_16x16x32_bf16 v[124:127], v[76:79], v[176:179], v[124:127]
  buffer_load_dwordx4 v[176:179], v10, s[24:27], s74 offen offset:2048 sc1
  s_waitcnt vmcnt(12)
  v_mfma_f32_16x16x32_bf16 v[128:131], v[96:99], v[196:199], v[128:131]
  v_mfma_f32_16x16x32_bf16 v[132:135], v[100:103], v[196:199], v[132:135]
  v_mfma_f32_16x16x32_bf16 v[136:139], v[104:107], v[196:199], v[136:139]
  v_mfma_f32_16x16x32_bf16 v[140:143], v[108:111], v[196:199], v[140:143]
  s_addk_i32 s75, 4096
  buffer_load_dwordx4 v[196:199], v10, s[24:27], s75 offen offset:0 sc1
  s_waitcnt vmcnt(12)
  v_mfma_f32_16x16x32_bf16 v[144:147], v[96:99], v[200:203], v[144:147]
  s_lshr_b32 s63, s37, 1
  s_mul_i32 s63, s63, 28672
  s_and_b32 s64, s37, 1
  s_lshl_b32 s64, s64, 8
  s_add_u32 s63, s63, s64
  s_lshl_b32 s64, s69, 12
  s_add_u32 s63, s63, s64
  s_add_u32 s63, s63, 8388608
  v_mfma_f32_16x16x32_bf16 v[148:151], v[100:103], v[200:203], v[148:151]
  buffer_load_dwordx4 v[72:75], v10, s[24:27], s63 offen sc1
  buffer_load_dwordx4 v[76:79], v10, s[24:27], s63 offen offset:2048 sc1
  s_lshl_b32 s64, s69, 7
  s_add_u32 s63, s64, 10880
  v_lshlrev_b32 v9, 4, v5
  v_mfma_f32_16x16x32_bf16 v[152:155], v[104:107], v[200:203], v[152:155]
  v_lshlrev_b32 v12, 2, v1
  s_mov_b32 exec_hi, 0
  buffer_load_dword v12, v12, s[24:27], s63 offen sc1
  s_mov_b32 exec_hi, -1
  v_mad_u32_u24 v11, v4, s34, v9
  s_mul_i32 s37, s37, 14336
  s_add_u32 s37, s37, s64
  v_mfma_f32_16x16x32_bf16 v[156:159], v[108:111], v[200:203], v[156:159]
  s_addk_i32 s76, 4096
  buffer_load_dwordx4 v[200:203], v10, s[24:27], s76 offen offset:0 sc1
  s_waitcnt vmcnt(15)
  v_mfma_f32_16x16x32_bf16 v[160:163], v[96:99], v[204:207], v[160:163]
  v_mfma_f32_16x16x32_bf16 v[164:167], v[100:103], v[204:207], v[164:167]
  v_mfma_f32_16x16x32_bf16 v[168:171], v[104:107], v[204:207], v[168:171]
  v_mfma_f32_16x16x32_bf16 v[172:175], v[108:111], v[204:207], v[172:175]
  s_addk_i32 s77, 4096
  buffer_load_dwordx4 v[204:207], v10, s[24:27], s77 offen offset:0 sc1
  s_waitcnt vmcnt(15)
  v_mfma_f32_16x16x32_bf16 v[112:115], v[96:99], v[192:195], v[112:115]
  v_mfma_f32_16x16x32_bf16 v[116:119], v[100:103], v[192:195], v[116:119]
  v_mfma_f32_16x16x32_bf16 v[120:123], v[104:107], v[192:195], v[120:123]
  v_mfma_f32_16x16x32_bf16 v[124:127], v[108:111], v[192:195], v[124:127]
  s_addk_i32 s74, 4096
  buffer_load_dwordx4 v[192:195], v10, s[24:27], s74 offen offset:0 sc1
  s_waitcnt vmcnt(15) lgkmcnt(11)
  v_mfma_f32_16x16x32_bf16 v[128:131], v[80:83], v[212:215], v[128:131]
  s_waitcnt lgkmcnt(10)
  v_mfma_f32_16x16x32_bf16 v[132:135], v[84:87], v[212:215], v[132:135]
  s_waitcnt lgkmcnt(9)
  v_mfma_f32_16x16x32_bf16 v[136:139], v[88:91], v[212:215], v[136:139]
  s_waitcnt lgkmcnt(8)
  v_mfma_f32_16x16x32_bf16 v[140:143], v[92:95], v[212:215], v[140:143]
  buffer_load_dwordx4 v[212:215], v10, s[24:27], s75 offen offset:2048 sc1
  s_waitcnt vmcnt(15)
  v_mfma_f32_16x16x32_bf16 v[144:147], v[80:83], v[216:219], v[144:147]
  v_mfma_f32_16x16x32_bf16 v[148:151], v[84:87], v[216:219], v[148:151]
  v_mfma_f32_16x16x32_bf16 v[152:155], v[88:91], v[216:219], v[152:155]
  v_mfma_f32_16x16x32_bf16 v[156:159], v[92:95], v[216:219], v[156:159]
  buffer_load_dwordx4 v[216:219], v10, s[24:27], s76 offen offset:2048 sc1
  s_waitcnt vmcnt(15)
  v_mfma_f32_16x16x32_bf16 v[160:163], v[80:83], v[220:223], v[160:163]
  v_mfma_f32_16x16x32_bf16 v[164:167], v[84:87], v[220:223], v[164:167]
  v_mfma_f32_16x16x32_bf16 v[168:171], v[88:91], v[220:223], v[168:171]
  v_mfma_f32_16x16x32_bf16 v[172:175], v[92:95], v[220:223], v[172:175]
  buffer_load_dwordx4 v[220:223], v10, s[24:27], s77 offen offset:2048 sc1
  s_waitcnt vmcnt(15)
  v_mfma_f32_16x16x32_bf16 v[112:115], v[80:83], v[208:211], v[112:115]
  v_mfma_f32_16x16x32_bf16 v[116:119], v[84:87], v[208:211], v[116:119]
  v_mfma_f32_16x16x32_bf16 v[120:123], v[88:91], v[208:211], v[120:123]
  v_mfma_f32_16x16x32_bf16 v[124:127], v[92:95], v[208:211], v[124:127]
  buffer_load_dwordx4 v[208:211], v10, s[24:27], s74 offen offset:2048 sc1
  s_waitcnt vmcnt(15) lgkmcnt(7)
  v_mfma_f32_16x16x32_bf16 v[128:131], v[240:243], v[180:183], v[128:131]
  s_waitcnt lgkmcnt(6)
  v_mfma_f32_16x16x32_bf16 v[132:135], v[244:247], v[180:183], v[132:135]
  s_waitcnt lgkmcnt(5)
  v_mfma_f32_16x16x32_bf16 v[136:139], v[248:251], v[180:183], v[136:139]
  s_waitcnt lgkmcnt(4)
  v_mfma_f32_16x16x32_bf16 v[140:143], v[252:255], v[180:183], v[140:143]
  s_waitcnt vmcnt(14)
  v_sub_u32 v7, v7, v14
  v_cmp_lt_u32 vcc, 4, v7
  s_cbranch_vccz Lhok_95
Lpoll_96:
  buffer_load_dword v7, v8, s[24:27], s36 offen sc1
  s_sub_u32 s59, s59, 1
  s_cmp_lt_i32 s59, 0
  s_cbranch_scc1 Lpdone_97
  s_waitcnt vmcnt(0)
  v_sub_u32 v7, v7, v14
  v_cmp_lt_u32 vcc, 4, v7
  s_cbranch_vccnz Lpoll_96
Lpdone_97:
Lhok_95:
  s_addk_i32 s75, 4096
  buffer_load_dwordx4 v[180:183], v10, s[24:27], s75 offen offset:0 sc1
  s_waitcnt vmcnt(14)
  v_mfma_f32_16x16x32_bf16 v[144:147], v[240:243], v[184:187], v[144:147]
  v_mfma_f32_16x16x32_bf16 v[148:151], v[244:247], v[184:187], v[148:151]
  v_mfma_f32_16x16x32_bf16 v[152:155], v[248:251], v[184:187], v[152:155]
  v_mfma_f32_16x16x32_bf16 v[156:159], v[252:255], v[184:187], v[156:159]
  s_addk_i32 s76, 4096
  buffer_load_dwordx4 v[184:187], v10, s[24:27], s76 offen offset:0 sc1
  s_waitcnt vmcnt(14)
  v_mfma_f32_16x16x32_bf16 v[160:163], v[240:243], v[188:191], v[160:163]
  v_mfma_f32_16x16x32_bf16 v[164:167], v[244:247], v[188:191], v[164:167]
  v_mfma_f32_16x16x32_bf16 v[168:171], v[248:251], v[188:191], v[168:171]
  v_mfma_f32_16x16x32_bf16 v[172:175], v[252:255], v[188:191], v[172:175]
  s_addk_i32 s77, 4096
  buffer_load_dwordx4 v[188:191], v10, s[24:27], s77 offen offset:0 sc1
  s_waitcnt vmcnt(14)
  v_mfma_f32_16x16x32_bf16 v[112:115], v[240:243], v[176:179], v[112:115]
  v_mfma_f32_16x16x32_bf16 v[116:119], v[244:247], v[176:179], v[116:119]
  v_mfma_f32_16x16x32_bf16 v[120:123], v[248:251], v[176:179], v[120:123]
  v_mfma_f32_16x16x32_bf16 v[124:127], v[252:255], v[176:179], v[124:127]
  s_addk_i32 s74, 4096
  buffer_load_dwordx4 v[176:179], v10, s[24:27], s74 offen offset:0 sc1
  s_waitcnt vmcnt(14) lgkmcnt(3)
  v_mfma_f32_16x16x32_bf16 v[128:131], v[32:35], v[196:199], v[128:131]
  s_waitcnt lgkmcnt(2)
  v_mfma_f32_16x16x32_bf16 v[132:135], v[36:39], v[196:199], v[132:135]
  s_waitcnt lgkmcnt(1)
  v_mfma_f32_16x16x32_bf16 v[136:139], v[40:43], v[196:199], v[136:139]
  s_waitcnt lgkmcnt(0)
  v_mfma_f32_16x16x32_bf16 v[140:143], v[44:47], v[196:199], v[140:143]
  buffer_load_dwordx4 v[196:199], v10, s[24:27], s75 offen offset:2048 sc1
  s_waitcnt vmcnt(11)
  v_mfma_f32_16x16x32_bf16 v[144:147], v[32:35], v[200:203], v[144:147]
  ds_bpermute_b32 v64, v9, v12 offset:0
  ds_bpermute_b32 v65, v9, v12 offset:4
  v_mfma_f32_16x16x32_bf16 v[148:151], v[36:39], v[200:203], v[148:151]
  ds_bpermute_b32 v66, v9, v12 offset:8
  ds_bpermute_b32 v67, v9, v12 offset:12
  v_mfma_f32_16x16x32_bf16 v[152:155], v[40:43], v[200:203], v[152:155]
  ds_bpermute_b32 v68, v9, v12 offset:64
  ds_bpermute_b32 v69, v9, v12 offset:68
  v_mfma_f32_16x16x32_bf16 v[156:159], v[44:47], v[200:203], v[156:159]
  ds_bpermute_b32 v70, v9, v12 offset:72
  ds_bpermute_b32 v71, v9, v12 offset:76
  buffer_load_dwordx4 v[200:203], v10, s[24:27], s76 offen offset:2048 sc1
  s_waitcnt vmcnt(11)
  v_mfma_f32_16x16x32_bf16 v[160:163], v[32:35], v[204:207], v[160:163]
  v_mfma_f32_16x16x32_bf16 v[164:167], v[36:39], v[204:207], v[164:167]
  v_mfma_f32_16x16x32_bf16 v[168:171], v[40:43], v[204:207], v[168:171]
  s_mul_i32 s64, s52, 12288
  s_add_u32 s64, s64, 86016
  v_add_u32 v9, s64, v2
  v_mfma_f32_16x16x32_bf16 v[172:175], v[44:47], v[204:207], v[172:175]
  s_waitcnt lgkmcnt(7)
  v_lshlrev_b32 v96, 16, v64
  v_and_b32 v97, 0xffff0000, v64
  buffer_load_dwordx4 v[204:207], v10, s[24:27], s77 offen offset:2048 sc1
  s_waitcnt vmcnt(11)
  v_mfma_f32_16x16x32_bf16 v[112:115], v[32:35], v[192:195], v[112:115]
  s_waitcnt lgkmcnt(6)
  v_lshlrev_b32 v98, 16, v65
  v_and_b32 v99, 0xffff0000, v65
  v_mfma_f32_16x16x32_bf16 v[116:119], v[36:39], v[192:195], v[116:119]
  s_waitcnt lgkmcnt(5)
  v_lshlrev_b32 v100, 16, v66
  v_and_b32 v101, 0xffff0000, v66
  v_mfma_f32_16x16x32_bf16 v[120:123], v[40:43], v[192:195], v[120:123]
  s_waitcnt lgkmcnt(4)
  v_lshlrev_b32 v102, 16, v67
  v_and_b32 v103, 0xffff0000, v67
  v_mfma_f32_16x16x32_bf16 v[124:127], v[44:47], v[192:195], v[124:127]
  s_waitcnt lgkmcnt(3)
  v_lshlrev_b32 v104, 16, v68
  v_and_b32 v105, 0xffff0000, v68
  buffer_load_dwordx4 v[192:195], v10, s[24:27], s74 offen offset:2048 sc1
  s_waitcnt vmcnt(11)
  v_mfma_f32_16x16x32_bf16 v[128:131], v[224:227], v[212:215], v[128:131]
  s_waitcnt lgkmcnt(2)
  v_lshlrev_b32 v106, 16, v69
  v_and_b32 v107, 0xffff0000, v69
  v_mfma_f32_16x16x32_bf16 v[132:135], v[228:231], v[212:215], v[132:135]
  s_waitcnt lgkmcnt(1)
  v_lshlrev_b32 v108, 16, v70
  v_and_b32 v109, 0xffff0000, v70
  v_mfma_f32_16x16x32_bf16 v[136:139], v[232:235], v[212:215], v[136:139]
  s_waitcnt lgkmcnt(0)
  v_lshlrev_b32 v110, 16, v71
  v_and_b32 v111, 0xffff0000, v71
  v_mfma_f32_16x16x32_bf16 v[140:143], v[236:239], v[212:215], v[140:143]
  v_lshlrev_b32 v80, 16, v72
  v_and_b32 v81, 0xffff0000, v72
  s_waitcnt vmcnt(10)
  v_mfma_f32_16x16x32_bf16 v[144:147], v[224:227], v[216:219], v[144:147]
  v_lshlrev_b32 v82, 16, v73
  v_and_b32 v83, 0xffff0000, v73
  v_mfma_f32_16x16x32_bf16 v[148:151], v[228:231], v[216:219], v[148:151]
  v_lshlrev_b32 v84, 16, v74
  v_and_b32 v85, 0xffff0000, v74
  v_mfma_f32_16x16x32_bf16 v[152:155], v[232:235], v[216:219], v[152:155]
  v_lshlrev_b32 v86, 16, v75
  v_and_b32 v87, 0xffff0000, v75
  v_mfma_f32_16x16x32_bf16 v[156:159], v[236:239], v[216:219], v[156:159]
  v_lshlrev_b32 v88, 16, v76
  v_and_b32 v89, 0xffff0000, v76
  s_waitcnt vmcnt(9)
  v_mfma_f32_16x16x32_bf16 v[160:163], v[224:227], v[220:223], v[160:163]
  v_lshlrev_b32 v90, 16, v77
  v_and_b32 v91, 0xffff0000, v77
  v_mfma_f32_16x16x32_bf16 v[164:167], v[228:231], v[220:223], v[164:167]
  v_lshlrev_b32 v92, 16, v78
  v_and_b32 v93, 0xffff0000, v78
  v_mfma_f32_16x16x32_bf16 v[168:171], v[232:235], v[220:223], v[168:171]
  v_lshlrev_b32 v94, 16, v79
  v_and_b32 v95, 0xffff0000, v79
  v_mfma_f32_16x16x32_bf16 v[172:175], v[236:239], v[220:223], v[172:175]
  s_waitcnt vmcnt(8)
  v_mfma_f32_16x16x32_bf16 v[112:115], v[224:227], v[208:211], v[112:115]
  s_xor_b32 s64, s52, 1
  s_mul_i32 s64, s64, 12288
  s_add_u32 s64, s64, 86016
  v_add_u32 v6, s64, v2
  v_mfma_f32_16x16x32_bf16 v[116:119], v[228:231], v[208:211], v[116:119]
  s_xor_b32 s64, s52, 2
  s_mul_i32 s64, s64, 12288
  s_add_u32 s64, s64, 90112
  v_add_u32 v7, s64, v2
  v_mfma_f32_16x16x32_bf16 v[120:123], v[232:235], v[208:211], v[120:123]
  s_xor_b32 s64, s52, 3
  s_mul_i32 s64, s64, 12288
  s_add_u32 s64, s64, 94208
  v_add_u32 v8, s64, v2
  v_mfma_f32_16x16x32_bf16 v[124:127], v[236:239], v[208:211], v[124:127]
  s_waitcnt vmcnt(7)
  v_mfma_f32_16x16x32_bf16 v[128:131], v[16:19], v[180:183], v[128:131]
  v_mfma_f32_16x16x32_bf16 v[132:135], v[20:23], v[180:183], v[132:135]
  v_mfma_f32_16x16x32_bf16 v[136:139], v[24:27], v[180:183], v[136:139]
  v_mfma_f32_16x16x32_bf16 v[140:143], v[28:31], v[180:183], v[140:143]
  s_waitcnt vmcnt(3)
  v_mfma_f32_16x16x32_bf16 v[128:131], v[48:51], v[196:199], v[128:131]
  v_mfma_f32_16x16x32_bf16 v[132:135], v[52:55], v[196:199], v[132:135]
  v_mfma_f32_16x16x32_bf16 v[136:139], v[56:59], v[196:199], v[136:139]
  v_mfma_f32_16x16x32_bf16 v[140:143], v[60:63], v[196:199], v[140:143]
  v_mfma_f32_16x16x32_bf16 v[144:147], v[16:19], v[184:187], v[144:147]
  v_mfma_f32_16x16x32_bf16 v[148:151], v[20:23], v[184:187], v[148:151]
  s_nop 2
  ds_write_b128 v6, v[128:131] offset:0
  v_mfma_f32_16x16x32_bf16 v[152:155], v[24:27], v[184:187], v[152:155]
  v_mfma_f32_16x16x32_bf16 v[156:159], v[28:31], v[184:187], v[156:159]
  ds_write_b128 v6, v[132:135] offset:1024
  s_waitcnt vmcnt(2)
  v_mfma_f32_16x16x32_bf16 v[144:147], v[48:51], v[200:203], v[144:147]
  v_mfma_f32_16x16x32_bf16 v[148:151], v[52:55], v[200:203], v[148:151]
  ds_write_b128 v6, v[136:139] offset:2048
  v_mfma_f32_16x16x32_bf16 v[152:155], v[56:59], v[200:203], v[152:155]
  v_mfma_f32_16x16x32_bf16 v[156:159], v[60:63], v[200:203], v[156:159]
  ds_write_b128 v6, v[140:143] offset:3072
  v_mfma_f32_16x16x32_bf16 v[160:163], v[16:19], v[188:191], v[160:163]
  v_mfma_f32_16x16x32_bf16 v[164:167], v[20:23], v[188:191], v[164:167]
  s_nop 0
  ds_write_b128 v7, v[144:147] offset:0
  v_mfma_f32_16x16x32_bf16 v[168:171], v[24:27], v[188:191], v[168:171]
  v_mfma_f32_16x16x32_bf16 v[172:175], v[28:31], v[188:191], v[172:175]
  ds_write_b128 v7, v[148:151] offset:1024
  s_waitcnt vmcnt(1)
  v_mfma_f32_16x16x32_bf16 v[160:163], v[48:51], v[204:207], v[160:163]
  v_mfma_f32_16x16x32_bf16 v[164:167], v[52:55], v[204:207], v[164:167]
  ds_write_b128 v7, v[152:155] offset:2048
  v_mfma_f32_16x16x32_bf16 v[168:171], v[56:59], v[204:207], v[168:171]
  v_mfma_f32_16x16x32_bf16 v[172:175], v[60:63], v[204:207], v[172:175]
  ds_write_b128 v7, v[156:159] offset:3072
  v_mfma_f32_16x16x32_bf16 v[112:115], v[16:19], v[176:179], v[112:115]
  v_mfma_f32_16x16x32_bf16 v[116:119], v[20:23], v[176:179], v[116:119]
  s_nop 0
  ds_write_b128 v8, v[160:163] offset:0
  v_mfma_f32_16x16x32_bf16 v[120:123], v[24:27], v[176:179], v[120:123]
  ds_write_b128 v8, v[164:167] offset:1024
  v_mfma_f32_16x16x32_bf16 v[124:127], v[28:31], v[176:179], v[124:127]
  ds_write_b128 v8, v[168:171] offset:2048
  s_waitcnt vmcnt(0)
  v_mfma_f32_16x16x32_bf16 v[112:115], v[48:51], v[192:195], v[112:115]
  ds_write_b128 v8, v[172:175] offset:3072
  v_mfma_f32_16x16x32_bf16 v[116:119], v[52:55], v[192:195], v[116:119]
  v_mfma_f32_16x16x32_bf16 v[120:123], v[56:59], v[192:195], v[120:123]
  v_mfma_f32_16x16x32_bf16 v[124:127], v[60:63], v[192:195], v[124:127]
  s_waitcnt lgkmcnt(0)
  s_barrier
  ds_read_b128 v[128:131], v9 offset:0
  ds_read_b128 v[144:147], v9 offset:4096
  ds_read_b128 v[160:163], v9 offset:8192
  ds_read_b128 v[132:135], v9 offset:1024
  ds_read_b128 v[148:151], v9 offset:5120
  ds_read_b128 v[164:167], v9 offset:9216
  ds_read_b128 v[136:139], v9 offset:2048
  ds_read_b128 v[152:155], v9 offset:6144
  ds_read_b128 v[168:171], v9 offset:10240
  ds_read_b128 v[140:143], v9 offset:3072
  ds_read_b128 v[156:159], v9 offset:7168
  ds_read_b128 v[172:175], v9 offset:11264
  s_waitcnt lgkmcnt(11)
  v_pk_add_f32 v[112:113], v[112:113], v[128:129]
  s_waitcnt lgkmcnt(9)
  v_pk_add_f32 v[144:145], v[144:145], v[160:161]
  v_pk_add_f32 v[114:115], v[114:115], v[130:131]
  v_pk_add_f32 v[146:147], v[146:147], v[162:163]
  s_waitcnt lgkmcnt(8)
  v_pk_add_f32 v[116:117], v[116:117], v[132:133]
  s_waitcnt lgkmcnt(6)
  v_pk_add_f32 v[148:149], v[148:149], v[164:165]
  v_pk_add_f32 v[118:119], v[118:119], v[134:135]
  v_pk_add_f32 v[150:151], v[150:151], v[166:167]
  v_pk_add_f32 v[112:113], v[112:113], v[144:145]
  v_pk_add_f32 v[114:115], v[114:115], v[146:147]
  v_pk_add_f32 v[116:117], v[116:117], v[148:149]
  v_pk_add_f32 v[118:119], v[118:119], v[150:151]
  v_pk_fma_f32 v[112:113], v[112:113], v[96:97], v[80:81]
  v_pk_fma_f32 v[114:115], v[114:115], v[98:99], v[82:83]
  v_pk_fma_f32 v[116:117], v[116:117], v[100:101], v[84:85]
  v_pk_fma_f32 v[118:119], v[118:119], v[102:103], v[86:87]
  v_cvt_pk_bf16_f32 v72, v112, v113
  v_cvt_pk_bf16_f32 v73, v114, v115
  v_cvt_pk_bf16_f32 v74, v116, v117
  v_cvt_pk_bf16_f32 v75, v118, v119
  buffer_store_dwordx4 v[72:75], v11, s[28:31], s37 offen offset:0 nt
  s_waitcnt lgkmcnt(5)
  v_pk_add_f32 v[120:121], v[120:121], v[136:137]
  s_waitcnt lgkmcnt(3)
  v_pk_add_f32 v[152:153], v[152:153], v[168:169]
  v_pk_add_f32 v[122:123], v[122:123], v[138:139]
  v_pk_add_f32 v[154:155], v[154:155], v[170:171]
  s_waitcnt lgkmcnt(2)
  v_pk_add_f32 v[124:125], v[124:125], v[140:141]
  s_waitcnt lgkmcnt(0)
  v_pk_add_f32 v[156:157], v[156:157], v[172:173]
  v_pk_add_f32 v[126:127], v[126:127], v[142:143]
  v_pk_add_f32 v[158:159], v[158:159], v[174:175]
  v_pk_add_f32 v[120:121], v[120:121], v[152:153]
  v_pk_add_f32 v[122:123], v[122:123], v[154:155]
  v_pk_add_f32 v[124:125], v[124:125], v[156:157]
  v_pk_add_f32 v[126:127], v[126:127], v[158:159]
  v_pk_fma_f32 v[120:121], v[120:121], v[104:105], v[88:89]
  v_pk_fma_f32 v[122:123], v[122:123], v[106:107], v[90:91]
  v_pk_fma_f32 v[124:125], v[124:125], v[108:109], v[92:93]
  v_pk_fma_f32 v[126:127], v[126:127], v[110:111], v[94:95]
  v_cvt_pk_bf16_f32 v76, v120, v121
  v_cvt_pk_bf16_f32 v77, v122, v123
  v_cvt_pk_bf16_f32 v78, v124, v125
  v_cvt_pk_bf16_f32 v79, v126, v127
  buffer_store_dwordx4 v[76:79], v11, s[28:31], s37 offen offset:64 nt
Llfin:
  s_endpgm
Lend:
  s_endpgm
Lslow_8:
  s_mov_b32 exec_lo, 0
  v_mov_b32 v190, 0
  v_mov_b32 v191, 0
  s_mov_b64 exec, -1
  v_mov_b32 v6, 0xff800000
  s_mov_b32 s63, 262144
Lsl1_98:
  buffer_load_dwordx4 v[96:99], v40, s[24:27], s63 offen sc1
  buffer_load_dwordx4 v[100:103], v40, s[24:27], s63 offen offset:1024 sc1
  s_waitcnt vmcnt(1)
  v_mfma_f32_32x32x16_bf16 v[64:79], v[96:99], v[184:187], 0
  s_waitcnt vmcnt(0)
  v_mfma_f32_32x32x16_bf16 v[64:79], v[100:103], v[188:191], v[64:79]
  s_nop 11
  v_max3_f32 v6, v6, v64, v65
  v_max3_f32 v6, v6, v66, v67
  v_max3_f32 v6, v6, v68, v69
  v_max3_f32 v6, v6, v70, v71
  v_max3_f32 v6, v6, v72, v73
  v_max3_f32 v6, v6, v74, v75
  v_max3_f32 v6, v6, v76, v77
  v_max3_f32 v6, v6, v78, v79
  s_add_u32 s63, s63, 4096
  s_cmp_lt_u32 s63, 524288
  s_cbranch_scc1 Lsl1_98
  v_mov_b32 v7, v6
  s_nop 1
  v_permlane32_swap_b32 v6, v7
  v_max_f32 v6, v6, v7
  v_sub_f32 v6, 0, v6
  v_and_b32 v7, 0xffff0000, v6
  v_sub_f32 v8, v6, v7
  v_and_b32 v9, 0xffff0000, v8
  v_sub_f32 v8, v8, v9
  s_mov_b32 exec_lo, 0
  v_cvt_pk_bf16_f32 v190, v7, v9
  v_cvt_pk_bf16_f32 v191, v8, 0
  s_mov_b64 exec, -1
  v_mov_b32 v240, 0
  v_mov_b32 v241, 0
  v_mov_b32 v242, 0
  v_mov_b32 v243, 0
  v_mov_b32 v244, 0
  v_mov_b32 v245, 0
  v_mov_b32 v246, 0
  v_mov_b32 v247, 0
  v_mov_b32 v248, 0
  v_mov_b32 v249, 0
  v_mov_b32 v250, 0
  v_mov_b32 v251, 0
  v_mov_b32 v252, 0
  v_mov_b32 v253, 0
  v_mov_b32 v254, 0
  v_mov_b32 v255, 0
  s_mov_b32 s63, 262144
Lsl2_99:
  buffer_load_dwordx4 v[96:99], v40, s[24:27], s63 offen offset:0 sc1
  buffer_load_dwordx4 v[100:103], v40, s[24:27], s63 offen offset:1024 sc1
  buffer_load_dwordx4 v[104:107], v40, s[24:27], s63 offen offset:2048 sc1
  buffer_load_dwordx4 v[108:111], v40, s[24:27], s63 offen offset:3072 sc1
  s_waitcnt vmcnt(3)
  v_mfma_f32_32x32x16_bf16 v[64:79], v[96:99], v[184:187], 0
  s_waitcnt vmcnt(2)
  v_mfma_f32_32x32x16_bf16 v[64:79], v[100:103], v[188:191], v[64:79]
  s_nop 11
  v_exp_f32 v64, v64
  v_exp_f32 v65, v65
  v_exp_f32 v66, v66
  v_exp_f32 v67, v67
  v_exp_f32 v68, v68
  v_exp_f32 v69, v69
  v_exp_f32 v70, v70
  v_exp_f32 v71, v71
  v_exp_f32 v72, v72
  v_exp_f32 v73, v73
  v_exp_f32 v74, v74
  v_exp_f32 v75, v75
  v_exp_f32 v76, v76
  v_exp_f32 v77, v77
  v_exp_f32 v78, v78
  v_exp_f32 v79, v79
  v_cvt_pk_bf16_f32 v12, v64, v65
  v_cvt_pk_bf16_f32 v13, v66, v67
  v_cvt_pk_bf16_f32 v14, v68, v69
  v_cvt_pk_bf16_f32 v15, v70, v71
  v_cvt_pk_bf16_f32 v16, v72, v73
  v_cvt_pk_bf16_f32 v17, v74, v75
  v_cvt_pk_bf16_f32 v18, v76, v77
  v_cvt_pk_bf16_f32 v19, v78, v79
  s_waitcnt vmcnt(1)
  v_mfma_f32_32x32x16_bf16 v[240:255], v[104:107], v[12:15], v[240:255]
  s_waitcnt vmcnt(0)
  v_mfma_f32_32x32x16_bf16 v[240:255], v[108:111], v[16:19], v[240:255]
  s_add_u32 s63, s63, 4096
  s_cmp_lt_u32 s63, 524288
  s_nop 7
  s_nop 7
  s_cbranch_scc1 Lsl2_99
  v_mov_b32 v6, v252
  v_mov_b32 v7, v252
  s_nop 1
  v_permlane32_swap_b32 v6, v7
  s_branch Lnorm_9
Lnl_10:
  buffer_store_dwordx4 v[12:15], v2, s[24:27], s67 offen sc1
  buffer_store_dwordx4 v[16:19], v2, s[24:27], s67 offen offset:1024 sc1
  s_branch Lnle_11
Lnl_12:
  buffer_store_dword v3, off, s[24:27], s68 sc1
  s_branch Lnle_13
Lnl_18:
  buffer_store_dword v14, off, s[24:27], s71 sc1
  s_branch Lnle_19
Lnl_20:
  buffer_store_dword v14, off, s[24:27], s71 sc1
  s_branch Lnle_21
Lnl_22:
  buffer_store_dword v14, off, s[24:27], s71 sc1
  s_branch Lnle_23
Lnl_24:
  buffer_store_dword v14, off, s[24:27], s71 sc1
  s_branch Lnle_25
Lnl_78:
  buffer_store_dwordx2 v[112:113], v15, s[24:27], s11 offen sc1
  s_branch Lnle_79
Lnl_82:
  buffer_store_dwordx4 v[192:195], v2, s[24:27], s63 offen sc1
  buffer_store_dwordx4 v[196:199], v2, s[24:27], s64 offen sc1
  s_branch Lnle_83
Lnl_84:
  buffer_store_dword v3, off, s[24:27], s66 sc1
  s_branch Lnle_85
Lcodeend:
.section .rodata,"a"
.p2align 6
.amdhsa_kernel adaLN_cond__grouped_kv_mqa__glu_gated_reglu__prompt_kernel
  .amdhsa_next_free_vgpr 256
  .amdhsa_next_free_sgpr 102
  .amdhsa_accum_offset 256
  .amdhsa_group_segment_fixed_size 0
  .amdhsa_kernarg_size 112
  .amdhsa_user_sgpr_count 2
  .amdhsa_user_sgpr_kernarg_segment_ptr 1
  .amdhsa_system_sgpr_workgroup_id_x 1
.end_amdhsa_kernel
```
